```python
import torch

def _softmax(x, axis=-1):
    return torch.softmax(x, dim=axis)

def _gelu(x):
    return torch.nn.functional.gelu(x, approximate='tanh')

def _silu(x):
    return torch.nn.functional.silu(x)

def _sigmoid(x):
    return torch.sigmoid(x)

def _layernorm(x, axis=-1, eps=1e-05):
    m = x.mean(dim=axis, keepdim=True)
    v = x.var(dim=axis, keepdim=True, unbiased=False)
    return (x - m) / torch.sqrt(v + eps)

def _scatter_add(tgt, idx, src, axis=0):
    return tgt.clone().index_add_(axis, idx, src)

def _segment_sum(src, seg, n):
    out = torch.zeros((n,) + src.shape[1:], dtype=src.dtype)
    return out.index_add_(0, seg, src)

def _pad(x, pw):
    flat = tuple((v for pair in reversed(pw) for v in pair))
    return torch.nn.functional.pad(x, flat)
kernel_name = 'adaLN_cond__mha_block_cached__swiglu_ffn__decode'

def setup_inputs():

    _w = lambda a: (lambda t: t.to(torch.bfloat16) if t.is_floating_point() else t)(torch.as_tensor(a))

    def _A_setup():
        B, Sq, D = (2, 1, 640)
        H, Sk, Dh = (32, 16384, 128)
        return {'x': _w((lambda *s: torch.randn(*s, dtype=torch.bfloat16) * 0.1)(B, Sq, D)), 'k_cache': _w((lambda *s: torch.randn(*s, dtype=torch.bfloat16) * 0.8)(B, H, Sk, Dh)), 'v_cache': _w((lambda *s: torch.randn(*s, dtype=torch.bfloat16) * 1.6)(B, H, Sk, Dh)), 'wq': _w((lambda *s: torch.randn(*s, dtype=torch.bfloat16) * 0.8)(D, H * Dh) * D ** (-0.5)), 'wo': _w((lambda *s: torch.randn(*s, dtype=torch.bfloat16) * 1.6)(H * Dh, D) * (H * Dh) ** (-0.5))}
    _A_in = _A_setup()

    def _B_setup():
        B, S, D, F = (2, 1, 640, 1728)
        return {'x': _w((lambda *s: torch.randn(*s, dtype=torch.bfloat16) * 0.1)(B, S, D)), 'w_gate': _w((lambda *s: torch.randn(*s, dtype=torch.bfloat16) * 0.1)(D, F)), 'w_up': _w((lambda *s: torch.randn(*s, dtype=torch.bfloat16) * 0.1)(D, F)), 'w_down': _w((lambda *s: torch.randn(*s, dtype=torch.bfloat16) * 0.1)(F, D))}
    _B_in = _B_setup()
    return {'A_x': _A_in['x'], 'A_k_cache': _A_in['k_cache'], 'A_v_cache': _A_in['v_cache'], 'A_wq': _A_in['wq'], 'A_wo': _A_in['wo'], 'B_x': _B_in['x'], 'B_w_gate': _B_in['w_gate'], 'B_w_up': _B_in['w_up'], 'B_w_down': _B_in['w_down'], 'c': _w((lambda *s: torch.randn(*s, dtype=torch.bfloat16) * 0.2)(2, 640) * 8.0), 'w_mod': _w((lambda *s: torch.randn(*s, dtype=torch.bfloat16) * 0.2)(640, 6 * 640) * 640 ** (-0.5) * 8.0)}

def reference(A_x, A_k_cache, A_v_cache, A_wq, A_wo, B_x, B_w_gate, B_w_up, B_w_down, c, w_mod):

    def _A_ref(x, k_cache, v_cache, wq, wo):
        B, Sq, D = x.shape
        H, Dh = (32, 128)
        q = (lambda x, *d: x.permute(*d))((x @ wq).reshape(B, Sq, H, Dh), 0, 2, 1, 3)
        scores = torch.einsum('bhqd,bhkd->bhqk', q, k_cache) * Dh ** (-0.5)
        p = _softmax(scores, axis=-1)
        o = torch.einsum('bhqk,bhkd->bhqd', p, v_cache)
        return (lambda x, *d: x.permute(*d))(o, 0, 2, 1, 3).reshape(B, Sq, H * Dh) @ wo

    def _B_ref(x, w_gate, w_up, w_down):
        g = _silu(x @ w_gate)
        u = x @ w_up
        return g * u @ w_down
    x = A_x
    mod = (_silu(c) @ w_mod).reshape(c.shape[0], 6, 1, -1)
    sa, ca, ga, sb, cb, gb = (mod[:, 0].clone(), mod[:, 1].clone(), mod[:, 2].clone(), mod[:, 3].clone(), mod[:, 4].clone(), mod[:, 5].clone())
    h = _layernorm(x, axis=-1) * (1 + ca) + sa
    x = x + ga * _A_ref(h, A_k_cache, A_v_cache, A_wq, A_wo)
    h = _layernorm(x, axis=-1) * (1 + cb) + sb
    x = x + gb * _B_ref(h, B_w_gate, B_w_up, B_w_down)
    return x
```

```asm
; @launch grid=(256,1,1) block=(512,1,1) lds=163840
.amdgcn_target "amdgcn-amd-amdhsa--gfx950"
.text
.globl adaLN_cond__mha_block_cached__swiglu_ffn__decode_kernel
.p2align 8
.type adaLN_cond__mha_block_cached__swiglu_ffn__decode_kernel,@function
adaLN_cond__mha_block_cached__swiglu_ffn__decode_kernel:
    s_cmp_ge_u32 s2, 256
    s_cbranch_scc1 Lend
    s_load_dwordx16 s[4:19], s[0:1], 0
    s_load_dwordx8 s[20:27], s[0:1], 64
    s_load_dwordx4 s[28:31], s[0:1], 96
    v_lshrrev_b32 v2, 6, v0
    v_and_b32 v1, 63, v0
    s_mov_b32 s37, 0xbfb8aa3b
    v_readfirstlane_b32 s3, v2
    s_mov_b32 s64, 0x05040100
    s_mov_b32 s65, 0x07060302
    s_cmp_ge_u32 s3, 4
    s_cbranch_scc1 Lhelper
    s_lshr_b32 s66, s2, 3
    s_lshl_b32 s66, s66, 22
    s_and_b32 s67, s2, 7
    s_lshl_b32 s67, s67, 6
    s_add_u32 s67, s67, s3
    s_waitcnt lgkmcnt(0)
    s_and_b32 s14, s2, 7
    s_lshl_b32 s14, s14, 5
    s_lshr_b32 s36, s2, 3
    s_add_u32 s14, s14, s36
    s_add_u32 s40, s6, s66
    s_addc_u32 s41, s7, 0
    s_and_b32 s41, s41, 0xffff
    s_mov_b32 s42, 0x8400000
    s_mov_b32 s43, 0x20000
    s_add_u32 s44, s8, s66
    s_addc_u32 s45, s9, 0
    s_and_b32 s45, s45, 0xffff
    s_mov_b32 s46, 0x8400000
    s_mov_b32 s47, 0x20000
    s_mov_b32 s60, s30
    s_and_b32 s61, s31, 0xffff
    s_mov_b32 s62, 11534336
    s_mov_b32 s63, 0x20000
    s_mul_i32 s51, s3, 32768
    v_lshrrev_b32 v142, 4, v1
    v_and_b32 v143, 15, v1
    v_lshlrev_b32 v144, 1, v142
    v_xor_b32 v144, v144, v143
    v_lshlrev_b32 v144, 4, v144
    v_lshl_add_u32 v2, v142, 8, v144
    v_xor_b32 v3, 0x80, v2
    v_and_b32 v144, 7, v143
    v_lshlrev_b32 v144, 1, v144
    v_xor_b32 v144, v144, v142
    v_lshlrev_b32 v144, 4, v144
    v_lshl_add_u32 v144, v143, 8, v144
    v_add_u32 v4, s51, v144
    v_xor_b32 v5, 64, v144
    v_add_u32 v5, s51, v5
    v_xor_b32 v6, 128, v144
    v_add_u32 v6, s51, v6
    v_xor_b32 v7, 192, v144
    v_add_u32 v7, s51, v7
    v_lshrrev_b32 v144, 2, v143
    v_lshl_add_u32 v144, v142, 2, v144
    v_and_b32 v145, 7, v144
    v_lshlrev_b32 v145, 5, v145
    v_lshl_add_u32 v144, v144, 8, v145
    v_and_b32 v145, 3, v143
    v_lshl_add_u32 v144, v145, 3, v144
    v_xor_b32 v8, 0, v144
    v_add_u32 v8, s51, v8
    v_xor_b32 v9, 32, v144
    v_add_u32 v9, s51, v9
    v_xor_b32 v10, 64, v144
    v_add_u32 v10, s51, v10
    v_xor_b32 v11, 96, v144
    v_add_u32 v11, s51, v11
    v_xor_b32 v12, 128, v144
    v_add_u32 v12, s51, v12
    v_xor_b32 v13, 160, v144
    v_add_u32 v13, s51, v13
    v_xor_b32 v14, 192, v144
    v_add_u32 v14, s51, v14
    v_xor_b32 v15, 224, v144
    v_add_u32 v15, s51, v15
    s_lshl_b32 s48, s3, 13
    s_mov_b32 s49, s48
    s_mov_b32 s52, 0x3e0293ee
    s_lshl_b32 s48, s67, 13
    s_mov_b32 s49, s48
    s_add_u32 m0, s51, 0
    s_add_u32 s50, s48, 4096
    buffer_load_dwordx4 v2, s[40:43], s48 offen offset:0 nt lds
    buffer_load_dwordx4 v3, s[40:43], s48 offen offset:1024 nt lds
    buffer_load_dwordx4 v2, s[40:43], s48 offen offset:2048 nt lds
    buffer_load_dwordx4 v3, s[40:43], s48 offen offset:3072 nt lds
    s_add_u32 m0, s51, 4096
    s_add_u32 s48, s48, 32768
    buffer_load_dwordx4 v2, s[40:43], s50 offen offset:0 nt lds
    buffer_load_dwordx4 v3, s[40:43], s50 offen offset:1024 nt lds
    buffer_load_dwordx4 v2, s[40:43], s50 offen offset:2048 nt lds
    buffer_load_dwordx4 v3, s[40:43], s50 offen offset:3072 nt lds
    s_barrier
    v_mov_b32 v140, 0xff800000
    v_mov_b32 v141, 0
    v_mov_b32 v96, 0
    v_mov_b32 v97, 0
    v_mov_b32 v98, 0
    v_mov_b32 v99, 0
    v_mov_b32 v100, 0
    v_mov_b32 v101, 0
    v_mov_b32 v102, 0
    v_mov_b32 v103, 0
    v_mov_b32 v104, 0
    v_mov_b32 v105, 0
    v_mov_b32 v106, 0
    v_mov_b32 v107, 0
    v_mov_b32 v108, 0
    v_mov_b32 v109, 0
    v_mov_b32 v110, 0
    v_mov_b32 v111, 0
    v_mov_b32 v112, 0
    v_mov_b32 v113, 0
    v_mov_b32 v114, 0
    v_mov_b32 v115, 0
    v_mov_b32 v116, 0
    v_mov_b32 v117, 0
    v_mov_b32 v118, 0
    v_mov_b32 v119, 0
    v_mov_b32 v120, 0
    v_mov_b32 v121, 0
    v_mov_b32 v122, 0
    v_mov_b32 v123, 0
    v_mov_b32 v124, 0
    v_mov_b32 v125, 0
    v_mov_b32 v126, 0
    v_mov_b32 v127, 0
    v_lshlrev_b32 v216, 4, v1
    v_add_u32 v216, s51, v216
    s_waitcnt vmcnt(0)
    s_add_u32 m0, s51, 8192
    s_add_u32 s50, s49, 4096
    buffer_load_dwordx4 v2, s[44:47], s49 offen offset:0 nt lds
    buffer_load_dwordx4 v3, s[44:47], s49 offen offset:1024 nt lds
    buffer_load_dwordx4 v2, s[44:47], s49 offen offset:2048 nt lds
    buffer_load_dwordx4 v3, s[44:47], s49 offen offset:3072 nt lds
    s_add_u32 m0, s51, 12288
    s_add_u32 s49, s49, 32768
    buffer_load_dwordx4 v2, s[44:47], s50 offen offset:0 nt lds
    buffer_load_dwordx4 v3, s[44:47], s50 offen offset:1024 nt lds
    buffer_load_dwordx4 v2, s[44:47], s50 offen offset:2048 nt lds
    buffer_load_dwordx4 v3, s[44:47], s50 offen offset:3072 nt lds
    s_waitcnt vmcnt(0)
    s_add_u32 m0, s51, 16384
    s_add_u32 s50, s48, 4096
    buffer_load_dwordx4 v2, s[40:43], s48 offen offset:0 nt lds
    buffer_load_dwordx4 v3, s[40:43], s48 offen offset:1024 nt lds
    buffer_load_dwordx4 v2, s[40:43], s48 offen offset:2048 nt lds
    buffer_load_dwordx4 v3, s[40:43], s48 offen offset:3072 nt lds
    s_add_u32 m0, s51, 20480
    s_add_u32 s48, s48, 32768
    buffer_load_dwordx4 v2, s[40:43], s50 offen offset:0 nt lds
    buffer_load_dwordx4 v3, s[40:43], s50 offen offset:1024 nt lds
    buffer_load_dwordx4 v2, s[40:43], s50 offen offset:2048 nt lds
    buffer_load_dwordx4 v3, s[40:43], s50 offen offset:3072 nt lds
    s_waitcnt vmcnt(0)
    s_add_u32 m0, s51, 24576
    s_add_u32 s50, s49, 4096
    buffer_load_dwordx4 v2, s[44:47], s49 offen offset:0 nt lds
    buffer_load_dwordx4 v3, s[44:47], s49 offen offset:1024 nt lds
    buffer_load_dwordx4 v2, s[44:47], s49 offen offset:2048 nt lds
    buffer_load_dwordx4 v3, s[44:47], s49 offen offset:3072 nt lds
    s_add_u32 m0, s51, 28672
    s_add_u32 s49, s49, 32768
    buffer_load_dwordx4 v2, s[44:47], s50 offen offset:0 nt lds
    buffer_load_dwordx4 v3, s[44:47], s50 offen offset:1024 nt lds
    buffer_load_dwordx4 v2, s[44:47], s50 offen offset:2048 nt lds
    buffer_load_dwordx4 v3, s[44:47], s50 offen offset:3072 nt lds
    s_waitcnt vmcnt(0)
    s_add_u32 s50, s48, 4096
    buffer_load_dwordx4 v[152:155], v2, s[40:43], s48 offen offset:0 nt
    buffer_load_dwordx4 v[156:159], v3, s[40:43], s48 offen offset:1024 nt
    buffer_load_dwordx4 v[160:163], v2, s[40:43], s48 offen offset:2048 nt
    buffer_load_dwordx4 v[164:167], v3, s[40:43], s48 offen offset:3072 nt
    s_add_u32 s48, s48, 32768
    buffer_load_dwordx4 v[168:171], v2, s[40:43], s50 offen offset:0 nt
    buffer_load_dwordx4 v[172:175], v3, s[40:43], s50 offen offset:1024 nt
    buffer_load_dwordx4 v[176:179], v2, s[40:43], s50 offen offset:2048 nt
    buffer_load_dwordx4 v[180:183], v3, s[40:43], s50 offen offset:3072 nt
    s_waitcnt vmcnt(0)
    s_add_u32 s50, s49, 4096
    buffer_load_dwordx4 v[184:187], v2, s[44:47], s49 offen offset:0 nt
    buffer_load_dwordx4 v[188:191], v3, s[44:47], s49 offen offset:1024 nt
    buffer_load_dwordx4 v[192:195], v2, s[44:47], s49 offen offset:2048 nt
    buffer_load_dwordx4 v[196:199], v3, s[44:47], s49 offen offset:3072 nt
    s_add_u32 s49, s49, 32768
    buffer_load_dwordx4 v[200:203], v2, s[44:47], s50 offen offset:0 nt
    buffer_load_dwordx4 v[204:207], v3, s[44:47], s50 offen offset:1024 nt
    buffer_load_dwordx4 v[208:211], v2, s[44:47], s50 offen offset:2048 nt
    buffer_load_dwordx4 v[212:215], v3, s[44:47], s50 offen offset:3072 nt
    s_waitcnt vmcnt(0)
    s_add_u32 s50, s48, 4096
    buffer_load_dwordx4 v[218:221], v2, s[40:43], s48 offen offset:0 nt
    buffer_load_dwordx4 v[222:225], v3, s[40:43], s48 offen offset:1024 nt
    buffer_load_dwordx4 v[226:229], v2, s[40:43], s48 offen offset:2048 nt
    buffer_load_dwordx4 v[230:233], v3, s[40:43], s48 offen offset:3072 nt
    s_add_u32 s48, s48, 32768
    buffer_load_dwordx4 v[234:237], v2, s[40:43], s50 offen offset:0 nt
    buffer_load_dwordx4 v[238:241], v3, s[40:43], s50 offen offset:1024 nt
    buffer_load_dwordx4 v[242:245], v2, s[40:43], s50 offen offset:2048 nt
    buffer_load_dwordx4 v[246:249], v3, s[40:43], s50 offen offset:3072 nt
    v_lshrrev_b32 v142, 4, v1
    v_lshlrev_b32 v142, 4, v142
    v_add_u32 v146, 160384, v142
    s_mul_i32 s36, s3, 528
    s_add_u32 s36, s36, 151552
    v_and_b32 v147, 15, v1
    v_lshl_add_u32 v147, v147, 2, s36
    s_barrier
    ds_read_b128 v[16:19], v146 offset:0
    ds_read_b128 v[20:23], v146 offset:64
    ds_read_b128 v[24:27], v146 offset:128
    ds_read_b128 v[28:31], v146 offset:192
    s_waitcnt lgkmcnt(0)
    s_waitcnt vmcnt(48)
    ds_read_b128 v[32:35], v4 offset:0
    ds_read_b128 v[36:39], v5 offset:0
    ds_read_b128 v[40:43], v6 offset:0
    ds_read_b128 v[44:47], v7 offset:0
    ds_read_b128 v[48:51], v4 offset:4096
    ds_read_b128 v[52:55], v5 offset:4096
    ds_read_b128 v[56:59], v6 offset:4096
    ds_read_b128 v[60:63], v7 offset:4096
    s_waitcnt lgkmcnt(3)
    s_waitcnt lgkmcnt(0)
    v_mfma_f32_16x16x32_bf16 v[128:131], v[32:35], v[16:19], 0
    s_waitcnt lgkmcnt(0)
    v_mfma_f32_16x16x32_bf16 v[132:135], v[48:51], v[16:19], 0
    v_mfma_f32_16x16x32_bf16 v[128:131], v[36:39], v[20:23], v[128:131]
    v_mfma_f32_16x16x32_bf16 v[132:135], v[52:55], v[20:23], v[132:135]
    v_mfma_f32_16x16x32_bf16 v[128:131], v[40:43], v[24:27], v[128:131]
    v_mfma_f32_16x16x32_bf16 v[132:135], v[56:59], v[24:27], v[132:135]
    v_mfma_f32_16x16x32_bf16 v[128:131], v[44:47], v[28:31], v[128:131]
    v_mfma_f32_16x16x32_bf16 v[132:135], v[60:63], v[28:31], v[132:135]
    s_waitcnt vmcnt(40)
    ds_read_b64_tr_b16 v[64:65], v8 offset:8192
    ds_read_b64_tr_b16 v[66:67], v8 offset:12288
    ds_read_b64_tr_b16 v[68:69], v9 offset:8192
    ds_read_b64_tr_b16 v[70:71], v9 offset:12288
    ds_read_b64_tr_b16 v[72:73], v10 offset:8192
    ds_read_b64_tr_b16 v[74:75], v10 offset:12288
    ds_read_b64_tr_b16 v[76:77], v11 offset:8192
    ds_read_b64_tr_b16 v[78:79], v11 offset:12288
    ds_read_b64_tr_b16 v[80:81], v12 offset:8192
    ds_read_b64_tr_b16 v[82:83], v12 offset:12288
    ds_read_b64_tr_b16 v[84:85], v13 offset:8192
    ds_read_b64_tr_b16 v[86:87], v13 offset:12288
    ds_read_b64_tr_b16 v[88:89], v14 offset:8192
    ds_read_b64_tr_b16 v[90:91], v14 offset:12288
    ds_read_b64_tr_b16 v[92:93], v15 offset:8192
    ds_read_b64_tr_b16 v[94:95], v15 offset:12288
    v_max3_f32 v142, v128, v129, v130
    v_max3_f32 v142, v142, v131, v132
    v_max3_f32 v142, v142, v133, v134
    v_max3_f32 v142, v142, v135, v140
    v_mov_b32 v143, v142
    s_nop 1
    v_permlane16_swap_b32 v142, v143
    v_max_f32 v142, v142, v143
    v_mov_b32 v143, v142
    s_nop 1
    v_permlane32_swap_b32 v142, v143
    v_max_f32 v142, v142, v143
    v_sub_f32 v144, v140, v142
    v_mul_f32 v144, s52, v144
    v_mov_b32 v140, v142
    v_exp_f32 v144, v144
    v_mul_f32 v145, s52, v142
    v_fma_f32 v128, v128, s52, -v145
    v_fma_f32 v129, v129, s52, -v145
    v_fma_f32 v130, v130, s52, -v145
    v_fma_f32 v131, v131, s52, -v145
    v_fma_f32 v132, v132, s52, -v145
    v_fma_f32 v133, v133, s52, -v145
    v_fma_f32 v134, v134, s52, -v145
    v_fma_f32 v135, v135, s52, -v145
    v_exp_f32 v128, v128
    v_exp_f32 v129, v129
    v_exp_f32 v130, v130
    v_exp_f32 v131, v131
    v_exp_f32 v132, v132
    v_exp_f32 v133, v133
    v_exp_f32 v134, v134
    v_exp_f32 v135, v135
    v_mul_f32 v141, v141, v144
    v_mul_f32 v96, v96, v144
    v_mul_f32 v100, v100, v144
    v_mul_f32 v104, v104, v144
    v_mul_f32 v108, v108, v144
    v_mul_f32 v112, v112, v144
    v_mul_f32 v116, v116, v144
    v_mul_f32 v120, v120, v144
    v_mul_f32 v124, v124, v144
    v_cvt_pk_bf16_f32 v136, v128, v129
    v_cvt_pk_bf16_f32 v137, v130, v131
    v_cvt_pk_bf16_f32 v138, v132, v133
    v_cvt_pk_bf16_f32 v139, v134, v135
    v_add_f32 v142, v128, v129
    v_add_f32 v143, v130, v131
    v_add_f32 v142, v142, v132
    v_add_f32 v143, v143, v133
    v_add_f32 v142, v142, v134
    v_add_f32 v143, v143, v135
    v_add_f32 v142, v142, v143
    v_add_f32 v141, v141, v142
    s_waitcnt lgkmcnt(0)
    v_mfma_f32_16x16x32_bf16 v[96:99], v[136:139], v[64:67], v[96:99]
    v_mfma_f32_16x16x32_bf16 v[100:103], v[136:139], v[68:71], v[100:103]
    v_mfma_f32_16x16x32_bf16 v[104:107], v[136:139], v[72:75], v[104:107]
    v_mfma_f32_16x16x32_bf16 v[108:111], v[136:139], v[76:79], v[108:111]
    v_mfma_f32_16x16x32_bf16 v[112:115], v[136:139], v[80:83], v[112:115]
    v_mfma_f32_16x16x32_bf16 v[116:119], v[136:139], v[84:87], v[116:119]
    v_mfma_f32_16x16x32_bf16 v[120:123], v[136:139], v[88:91], v[120:123]
    v_mfma_f32_16x16x32_bf16 v[124:127], v[136:139], v[92:95], v[124:127]
    s_add_u32 m0, s51, 8192
    s_add_u32 s50, s49, 4096
    buffer_load_dwordx4 v2, s[44:47], s49 offen offset:0 nt lds
    buffer_load_dwordx4 v3, s[44:47], s49 offen offset:1024 nt lds
    buffer_load_dwordx4 v2, s[44:47], s49 offen offset:2048 nt lds
    buffer_load_dwordx4 v3, s[44:47], s49 offen offset:3072 nt lds
    s_add_u32 m0, s51, 12288
    s_add_u32 s49, s49, 32768
    buffer_load_dwordx4 v2, s[44:47], s50 offen offset:0 nt lds
    buffer_load_dwordx4 v3, s[44:47], s50 offen offset:1024 nt lds
    buffer_load_dwordx4 v2, s[44:47], s50 offen offset:2048 nt lds
    buffer_load_dwordx4 v3, s[44:47], s50 offen offset:3072 nt lds
    s_waitcnt vmcnt(8)
    ds_write_b128 v216, v[218:221] offset:0
    ds_write_b128 v216, v[222:225] offset:1024
    ds_write_b128 v216, v[226:229] offset:2048
    ds_write_b128 v216, v[230:233] offset:3072
    ds_write_b128 v216, v[234:237] offset:4096
    ds_write_b128 v216, v[238:241] offset:5120
    ds_write_b128 v216, v[242:245] offset:6144
    ds_write_b128 v216, v[246:249] offset:7168
    s_waitcnt vmcnt(8)
    ds_read_b128 v[32:35], v4 offset:16384
    ds_read_b128 v[36:39], v5 offset:16384
    ds_read_b128 v[40:43], v6 offset:16384
    ds_read_b128 v[44:47], v7 offset:16384
    ds_read_b128 v[48:51], v4 offset:20480
    ds_read_b128 v[52:55], v5 offset:20480
    ds_read_b128 v[56:59], v6 offset:20480
    ds_read_b128 v[60:63], v7 offset:20480
    s_waitcnt lgkmcnt(3)
    s_waitcnt lgkmcnt(0)
    v_mfma_f32_16x16x32_bf16 v[128:131], v[32:35], v[16:19], 0
    s_waitcnt lgkmcnt(0)
    v_mfma_f32_16x16x32_bf16 v[132:135], v[48:51], v[16:19], 0
    v_mfma_f32_16x16x32_bf16 v[128:131], v[36:39], v[20:23], v[128:131]
    v_mfma_f32_16x16x32_bf16 v[132:135], v[52:55], v[20:23], v[132:135]
    v_mfma_f32_16x16x32_bf16 v[128:131], v[40:43], v[24:27], v[128:131]
    v_mfma_f32_16x16x32_bf16 v[132:135], v[56:59], v[24:27], v[132:135]
    v_mfma_f32_16x16x32_bf16 v[128:131], v[44:47], v[28:31], v[128:131]
    v_mfma_f32_16x16x32_bf16 v[132:135], v[60:63], v[28:31], v[132:135]
    ds_write_b128 v216, v[152:155] offset:16384
    ds_write_b128 v216, v[156:159] offset:17408
    ds_write_b128 v216, v[160:163] offset:18432
    ds_write_b128 v216, v[164:167] offset:19456
    ds_write_b128 v216, v[168:171] offset:20480
    ds_write_b128 v216, v[172:175] offset:21504
    ds_write_b128 v216, v[176:179] offset:22528
    ds_write_b128 v216, v[180:183] offset:23552
    s_waitcnt vmcnt(8)
    ds_read_b64_tr_b16 v[64:65], v8 offset:24576
    ds_read_b64_tr_b16 v[66:67], v8 offset:28672
    ds_read_b64_tr_b16 v[68:69], v9 offset:24576
    ds_read_b64_tr_b16 v[70:71], v9 offset:28672
    ds_read_b64_tr_b16 v[72:73], v10 offset:24576
    ds_read_b64_tr_b16 v[74:75], v10 offset:28672
    ds_read_b64_tr_b16 v[76:77], v11 offset:24576
    ds_read_b64_tr_b16 v[78:79], v11 offset:28672
    ds_read_b64_tr_b16 v[80:81], v12 offset:24576
    ds_read_b64_tr_b16 v[82:83], v12 offset:28672
    ds_read_b64_tr_b16 v[84:85], v13 offset:24576
    ds_read_b64_tr_b16 v[86:87], v13 offset:28672
    ds_read_b64_tr_b16 v[88:89], v14 offset:24576
    ds_read_b64_tr_b16 v[90:91], v14 offset:28672
    ds_read_b64_tr_b16 v[92:93], v15 offset:24576
    ds_read_b64_tr_b16 v[94:95], v15 offset:28672
    v_max3_f32 v142, v128, v129, v130
    v_max3_f32 v142, v142, v131, v132
    v_max3_f32 v142, v142, v133, v134
    v_max3_f32 v142, v142, v135, v140
    v_mov_b32 v143, v142
    s_nop 1
    v_permlane16_swap_b32 v142, v143
    v_max_f32 v142, v142, v143
    v_mov_b32 v143, v142
    s_nop 1
    v_permlane32_swap_b32 v142, v143
    v_max_f32 v142, v142, v143
    v_sub_f32 v144, v140, v142
    v_mul_f32 v144, s52, v144
    v_mov_b32 v140, v142
    v_exp_f32 v144, v144
    v_mul_f32 v145, s52, v142
    v_fma_f32 v128, v128, s52, -v145
    v_fma_f32 v129, v129, s52, -v145
    v_fma_f32 v130, v130, s52, -v145
    v_fma_f32 v131, v131, s52, -v145
    v_fma_f32 v132, v132, s52, -v145
    v_fma_f32 v133, v133, s52, -v145
    v_fma_f32 v134, v134, s52, -v145
    v_fma_f32 v135, v135, s52, -v145
    v_exp_f32 v128, v128
    v_exp_f32 v129, v129
    v_exp_f32 v130, v130
    v_exp_f32 v131, v131
    v_exp_f32 v132, v132
    v_exp_f32 v133, v133
    v_exp_f32 v134, v134
    v_exp_f32 v135, v135
    v_mul_f32 v141, v141, v144
    v_mul_f32 v96, v96, v144
    v_mul_f32 v100, v100, v144
    v_mul_f32 v104, v104, v144
    v_mul_f32 v108, v108, v144
    v_mul_f32 v112, v112, v144
    v_mul_f32 v116, v116, v144
    v_mul_f32 v120, v120, v144
    v_mul_f32 v124, v124, v144
    v_cvt_pk_bf16_f32 v136, v128, v129
    v_cvt_pk_bf16_f32 v137, v130, v131
    v_cvt_pk_bf16_f32 v138, v132, v133
    v_cvt_pk_bf16_f32 v139, v134, v135
    v_add_f32 v142, v128, v129
    v_add_f32 v143, v130, v131
    v_add_f32 v142, v142, v132
    v_add_f32 v143, v143, v133
    v_add_f32 v142, v142, v134
    v_add_f32 v143, v143, v135
    v_add_f32 v142, v142, v143
    v_add_f32 v141, v141, v142
    s_waitcnt lgkmcnt(0)
    v_mfma_f32_16x16x32_bf16 v[96:99], v[136:139], v[64:67], v[96:99]
    v_mfma_f32_16x16x32_bf16 v[100:103], v[136:139], v[68:71], v[100:103]
    v_mfma_f32_16x16x32_bf16 v[104:107], v[136:139], v[72:75], v[104:107]
    v_mfma_f32_16x16x32_bf16 v[108:111], v[136:139], v[76:79], v[108:111]
    v_mfma_f32_16x16x32_bf16 v[112:115], v[136:139], v[80:83], v[112:115]
    v_mfma_f32_16x16x32_bf16 v[116:119], v[136:139], v[84:87], v[116:119]
    v_mfma_f32_16x16x32_bf16 v[120:123], v[136:139], v[88:91], v[120:123]
    v_mfma_f32_16x16x32_bf16 v[124:127], v[136:139], v[92:95], v[124:127]
    ds_write_b128 v216, v[184:187] offset:24576
    ds_write_b128 v216, v[188:191] offset:25600
    ds_write_b128 v216, v[192:195] offset:26624
    ds_write_b128 v216, v[196:199] offset:27648
    ds_write_b128 v216, v[200:203] offset:28672
    ds_write_b128 v216, v[204:207] offset:29696
    ds_write_b128 v216, v[208:211] offset:30720
    ds_write_b128 v216, v[212:215] offset:31744
    s_waitcnt vmcnt(8)
    ds_read_b128 v[32:35], v4 offset:0
    ds_read_b128 v[36:39], v5 offset:0
    ds_read_b128 v[40:43], v6 offset:0
    ds_read_b128 v[44:47], v7 offset:0
    ds_read_b128 v[48:51], v4 offset:4096
    ds_read_b128 v[52:55], v5 offset:4096
    ds_read_b128 v[56:59], v6 offset:4096
    ds_read_b128 v[60:63], v7 offset:4096
    s_waitcnt lgkmcnt(3)
    s_waitcnt lgkmcnt(0)
    v_mfma_f32_16x16x32_bf16 v[128:131], v[32:35], v[16:19], 0
    s_waitcnt lgkmcnt(0)
    v_mfma_f32_16x16x32_bf16 v[132:135], v[48:51], v[16:19], 0
    v_mfma_f32_16x16x32_bf16 v[128:131], v[36:39], v[20:23], v[128:131]
    v_mfma_f32_16x16x32_bf16 v[132:135], v[52:55], v[20:23], v[132:135]
    v_mfma_f32_16x16x32_bf16 v[128:131], v[40:43], v[24:27], v[128:131]
    v_mfma_f32_16x16x32_bf16 v[132:135], v[56:59], v[24:27], v[132:135]
    v_mfma_f32_16x16x32_bf16 v[128:131], v[44:47], v[28:31], v[128:131]
    v_mfma_f32_16x16x32_bf16 v[132:135], v[60:63], v[28:31], v[132:135]
    s_add_u32 m0, s51, 0
    s_add_u32 s50, s48, 4096
    buffer_load_dwordx4 v2, s[40:43], s48 offen offset:0 nt lds
    buffer_load_dwordx4 v3, s[40:43], s48 offen offset:1024 nt lds
    buffer_load_dwordx4 v2, s[40:43], s48 offen offset:2048 nt lds
    buffer_load_dwordx4 v3, s[40:43], s48 offen offset:3072 nt lds
    s_add_u32 m0, s51, 4096
    s_add_u32 s48, s48, 32768
    buffer_load_dwordx4 v2, s[40:43], s50 offen offset:0 nt lds
    buffer_load_dwordx4 v3, s[40:43], s50 offen offset:1024 nt lds
    buffer_load_dwordx4 v2, s[40:43], s50 offen offset:2048 nt lds
    buffer_load_dwordx4 v3, s[40:43], s50 offen offset:3072 nt lds
    s_waitcnt vmcnt(8)
    ds_read_b64_tr_b16 v[64:65], v8 offset:8192
    ds_read_b64_tr_b16 v[66:67], v8 offset:12288
    ds_read_b64_tr_b16 v[68:69], v9 offset:8192
    ds_read_b64_tr_b16 v[70:71], v9 offset:12288
    ds_read_b64_tr_b16 v[72:73], v10 offset:8192
    ds_read_b64_tr_b16 v[74:75], v10 offset:12288
    ds_read_b64_tr_b16 v[76:77], v11 offset:8192
    ds_read_b64_tr_b16 v[78:79], v11 offset:12288
    ds_read_b64_tr_b16 v[80:81], v12 offset:8192
    ds_read_b64_tr_b16 v[82:83], v12 offset:12288
    ds_read_b64_tr_b16 v[84:85], v13 offset:8192
    ds_read_b64_tr_b16 v[86:87], v13 offset:12288
    ds_read_b64_tr_b16 v[88:89], v14 offset:8192
    ds_read_b64_tr_b16 v[90:91], v14 offset:12288
    ds_read_b64_tr_b16 v[92:93], v15 offset:8192
    ds_read_b64_tr_b16 v[94:95], v15 offset:12288
    v_max3_f32 v142, v128, v129, v130
    v_max3_f32 v142, v142, v131, v132
    v_max3_f32 v142, v142, v133, v134
    v_max3_f32 v142, v142, v135, v140
    v_mov_b32 v143, v142
    s_nop 1
    v_permlane16_swap_b32 v142, v143
    v_max_f32 v142, v142, v143
    v_mov_b32 v143, v142
    s_nop 1
    v_permlane32_swap_b32 v142, v143
    v_max_f32 v142, v142, v143
    v_sub_f32 v144, v140, v142
    v_mul_f32 v144, s52, v144
    v_mov_b32 v140, v142
    v_exp_f32 v144, v144
    v_mul_f32 v145, s52, v142
    v_fma_f32 v128, v128, s52, -v145
    v_fma_f32 v129, v129, s52, -v145
    v_fma_f32 v130, v130, s52, -v145
    v_fma_f32 v131, v131, s52, -v145
    v_fma_f32 v132, v132, s52, -v145
    v_fma_f32 v133, v133, s52, -v145
    v_fma_f32 v134, v134, s52, -v145
    v_fma_f32 v135, v135, s52, -v145
    v_exp_f32 v128, v128
    v_exp_f32 v129, v129
    v_exp_f32 v130, v130
    v_exp_f32 v131, v131
    v_exp_f32 v132, v132
    v_exp_f32 v133, v133
    v_exp_f32 v134, v134
    v_exp_f32 v135, v135
    v_mul_f32 v141, v141, v144
    v_mul_f32 v96, v96, v144
    v_mul_f32 v100, v100, v144
    v_mul_f32 v104, v104, v144
    v_mul_f32 v108, v108, v144
    v_mul_f32 v112, v112, v144
    v_mul_f32 v116, v116, v144
    v_mul_f32 v120, v120, v144
    v_mul_f32 v124, v124, v144
    v_cvt_pk_bf16_f32 v136, v128, v129
    v_cvt_pk_bf16_f32 v137, v130, v131
    v_cvt_pk_bf16_f32 v138, v132, v133
    v_cvt_pk_bf16_f32 v139, v134, v135
    v_add_f32 v142, v128, v129
    v_add_f32 v143, v130, v131
    v_add_f32 v142, v142, v132
    v_add_f32 v143, v143, v133
    v_add_f32 v142, v142, v134
    v_add_f32 v143, v143, v135
    v_add_f32 v142, v142, v143
    v_add_f32 v141, v141, v142
    s_waitcnt lgkmcnt(0)
    v_mfma_f32_16x16x32_bf16 v[96:99], v[136:139], v[64:67], v[96:99]
    v_mfma_f32_16x16x32_bf16 v[100:103], v[136:139], v[68:71], v[100:103]
    v_mfma_f32_16x16x32_bf16 v[104:107], v[136:139], v[72:75], v[104:107]
    v_mfma_f32_16x16x32_bf16 v[108:111], v[136:139], v[76:79], v[108:111]
    v_mfma_f32_16x16x32_bf16 v[112:115], v[136:139], v[80:83], v[112:115]
    v_mfma_f32_16x16x32_bf16 v[116:119], v[136:139], v[84:87], v[116:119]
    v_mfma_f32_16x16x32_bf16 v[120:123], v[136:139], v[88:91], v[120:123]
    v_mfma_f32_16x16x32_bf16 v[124:127], v[136:139], v[92:95], v[124:127]
    s_add_u32 m0, s51, 8192
    s_add_u32 s50, s49, 4096
    buffer_load_dwordx4 v2, s[44:47], s49 offen offset:0 nt lds
    buffer_load_dwordx4 v3, s[44:47], s49 offen offset:1024 nt lds
    buffer_load_dwordx4 v2, s[44:47], s49 offen offset:2048 nt lds
    buffer_load_dwordx4 v3, s[44:47], s49 offen offset:3072 nt lds
    s_add_u32 m0, s51, 12288
    s_add_u32 s49, s49, 32768
    buffer_load_dwordx4 v2, s[44:47], s50 offen offset:0 nt lds
    buffer_load_dwordx4 v3, s[44:47], s50 offen offset:1024 nt lds
    buffer_load_dwordx4 v2, s[44:47], s50 offen offset:2048 nt lds
    buffer_load_dwordx4 v3, s[44:47], s50 offen offset:3072 nt lds
    s_waitcnt vmcnt(24)
    ds_read_b128 v[32:35], v4 offset:16384
    ds_read_b128 v[36:39], v5 offset:16384
    ds_read_b128 v[40:43], v6 offset:16384
    ds_read_b128 v[44:47], v7 offset:16384
    ds_read_b128 v[48:51], v4 offset:20480
    ds_read_b128 v[52:55], v5 offset:20480
    ds_read_b128 v[56:59], v6 offset:20480
    ds_read_b128 v[60:63], v7 offset:20480
    s_waitcnt lgkmcnt(3)
    s_waitcnt lgkmcnt(0)
    v_mfma_f32_16x16x32_bf16 v[128:131], v[32:35], v[16:19], 0
    s_waitcnt lgkmcnt(0)
    v_mfma_f32_16x16x32_bf16 v[132:135], v[48:51], v[16:19], 0
    v_mfma_f32_16x16x32_bf16 v[128:131], v[36:39], v[20:23], v[128:131]
    v_mfma_f32_16x16x32_bf16 v[132:135], v[52:55], v[20:23], v[132:135]
    v_mfma_f32_16x16x32_bf16 v[128:131], v[40:43], v[24:27], v[128:131]
    v_mfma_f32_16x16x32_bf16 v[132:135], v[56:59], v[24:27], v[132:135]
    v_mfma_f32_16x16x32_bf16 v[128:131], v[44:47], v[28:31], v[128:131]
    v_mfma_f32_16x16x32_bf16 v[132:135], v[60:63], v[28:31], v[132:135]
    s_add_u32 m0, s51, 16384
    s_add_u32 s50, s48, 4096
    buffer_load_dwordx4 v2, s[40:43], s48 offen offset:0 nt lds
    buffer_load_dwordx4 v3, s[40:43], s48 offen offset:1024 nt lds
    buffer_load_dwordx4 v2, s[40:43], s48 offen offset:2048 nt lds
    buffer_load_dwordx4 v3, s[40:43], s48 offen offset:3072 nt lds
    s_add_u32 m0, s51, 20480
    s_add_u32 s48, s48, 32768
    buffer_load_dwordx4 v2, s[40:43], s50 offen offset:0 nt lds
    buffer_load_dwordx4 v3, s[40:43], s50 offen offset:1024 nt lds
    buffer_load_dwordx4 v2, s[40:43], s50 offen offset:2048 nt lds
    buffer_load_dwordx4 v3, s[40:43], s50 offen offset:3072 nt lds
    s_waitcnt vmcnt(24)
    ds_read_b64_tr_b16 v[64:65], v8 offset:24576
    ds_read_b64_tr_b16 v[66:67], v8 offset:28672
    ds_read_b64_tr_b16 v[68:69], v9 offset:24576
    ds_read_b64_tr_b16 v[70:71], v9 offset:28672
    ds_read_b64_tr_b16 v[72:73], v10 offset:24576
    ds_read_b64_tr_b16 v[74:75], v10 offset:28672
    ds_read_b64_tr_b16 v[76:77], v11 offset:24576
    ds_read_b64_tr_b16 v[78:79], v11 offset:28672
    ds_read_b64_tr_b16 v[80:81], v12 offset:24576
    ds_read_b64_tr_b16 v[82:83], v12 offset:28672
    ds_read_b64_tr_b16 v[84:85], v13 offset:24576
    ds_read_b64_tr_b16 v[86:87], v13 offset:28672
    ds_read_b64_tr_b16 v[88:89], v14 offset:24576
    ds_read_b64_tr_b16 v[90:91], v14 offset:28672
    ds_read_b64_tr_b16 v[92:93], v15 offset:24576
    ds_read_b64_tr_b16 v[94:95], v15 offset:28672
    v_max3_f32 v142, v128, v129, v130
    v_max3_f32 v142, v142, v131, v132
    v_max3_f32 v142, v142, v133, v134
    v_max3_f32 v142, v142, v135, v140
    v_mov_b32 v143, v142
    s_nop 1
    v_permlane16_swap_b32 v142, v143
    v_max_f32 v142, v142, v143
    v_mov_b32 v143, v142
    s_nop 1
    v_permlane32_swap_b32 v142, v143
    v_max_f32 v142, v142, v143
    v_sub_f32 v144, v140, v142
    v_mul_f32 v144, s52, v144
    v_mov_b32 v140, v142
    v_exp_f32 v144, v144
    v_mul_f32 v145, s52, v142
    v_fma_f32 v128, v128, s52, -v145
    v_fma_f32 v129, v129, s52, -v145
    v_fma_f32 v130, v130, s52, -v145
    v_fma_f32 v131, v131, s52, -v145
    v_fma_f32 v132, v132, s52, -v145
    v_fma_f32 v133, v133, s52, -v145
    v_fma_f32 v134, v134, s52, -v145
    v_fma_f32 v135, v135, s52, -v145
    v_exp_f32 v128, v128
    v_exp_f32 v129, v129
    v_exp_f32 v130, v130
    v_exp_f32 v131, v131
    v_exp_f32 v132, v132
    v_exp_f32 v133, v133
    v_exp_f32 v134, v134
    v_exp_f32 v135, v135
    v_mul_f32 v141, v141, v144
    v_mul_f32 v96, v96, v144
    v_mul_f32 v100, v100, v144
    v_mul_f32 v104, v104, v144
    v_mul_f32 v108, v108, v144
    v_mul_f32 v112, v112, v144
    v_mul_f32 v116, v116, v144
    v_mul_f32 v120, v120, v144
    v_mul_f32 v124, v124, v144
    v_cvt_pk_bf16_f32 v136, v128, v129
    v_cvt_pk_bf16_f32 v137, v130, v131
    v_cvt_pk_bf16_f32 v138, v132, v133
    v_cvt_pk_bf16_f32 v139, v134, v135
    v_add_f32 v142, v128, v129
    v_add_f32 v143, v130, v131
    v_add_f32 v142, v142, v132
    v_add_f32 v143, v143, v133
    v_add_f32 v142, v142, v134
    v_add_f32 v143, v143, v135
    v_add_f32 v142, v142, v143
    v_add_f32 v141, v141, v142
    s_waitcnt lgkmcnt(0)
    v_mfma_f32_16x16x32_bf16 v[96:99], v[136:139], v[64:67], v[96:99]
    v_mfma_f32_16x16x32_bf16 v[100:103], v[136:139], v[68:71], v[100:103]
    v_mfma_f32_16x16x32_bf16 v[104:107], v[136:139], v[72:75], v[104:107]
    v_mfma_f32_16x16x32_bf16 v[108:111], v[136:139], v[76:79], v[108:111]
    v_mfma_f32_16x16x32_bf16 v[112:115], v[136:139], v[80:83], v[112:115]
    v_mfma_f32_16x16x32_bf16 v[116:119], v[136:139], v[84:87], v[116:119]
    v_mfma_f32_16x16x32_bf16 v[120:123], v[136:139], v[88:91], v[120:123]
    v_mfma_f32_16x16x32_bf16 v[124:127], v[136:139], v[92:95], v[124:127]
    s_add_u32 m0, s51, 24576
    s_add_u32 s50, s49, 4096
    buffer_load_dwordx4 v2, s[44:47], s49 offen offset:0 nt lds
    buffer_load_dwordx4 v3, s[44:47], s49 offen offset:1024 nt lds
    buffer_load_dwordx4 v2, s[44:47], s49 offen offset:2048 nt lds
    buffer_load_dwordx4 v3, s[44:47], s49 offen offset:3072 nt lds
    s_add_u32 m0, s51, 28672
    s_add_u32 s49, s49, 32768
    buffer_load_dwordx4 v2, s[44:47], s50 offen offset:0 nt lds
    buffer_load_dwordx4 v3, s[44:47], s50 offen offset:1024 nt lds
    buffer_load_dwordx4 v2, s[44:47], s50 offen offset:2048 nt lds
    buffer_load_dwordx4 v3, s[44:47], s50 offen offset:3072 nt lds
    s_mov_b32 s53, 6
Lloop_1:
    s_waitcnt vmcnt(24)
    ds_read_b128 v[32:35], v4 offset:0
    ds_read_b128 v[36:39], v5 offset:0
    ds_read_b128 v[40:43], v6 offset:0
    ds_read_b128 v[44:47], v7 offset:0
    ds_read_b128 v[48:51], v4 offset:4096
    ds_read_b128 v[52:55], v5 offset:4096
    ds_read_b128 v[56:59], v6 offset:4096
    ds_read_b128 v[60:63], v7 offset:4096
    s_waitcnt lgkmcnt(3)
    s_waitcnt lgkmcnt(0)
    v_mfma_f32_16x16x32_bf16 v[128:131], v[32:35], v[16:19], 0
    s_waitcnt lgkmcnt(0)
    v_mfma_f32_16x16x32_bf16 v[132:135], v[48:51], v[16:19], 0
    v_mfma_f32_16x16x32_bf16 v[128:131], v[36:39], v[20:23], v[128:131]
    v_mfma_f32_16x16x32_bf16 v[132:135], v[52:55], v[20:23], v[132:135]
    v_mfma_f32_16x16x32_bf16 v[128:131], v[40:43], v[24:27], v[128:131]
    v_mfma_f32_16x16x32_bf16 v[132:135], v[56:59], v[24:27], v[132:135]
    v_mfma_f32_16x16x32_bf16 v[128:131], v[44:47], v[28:31], v[128:131]
    v_mfma_f32_16x16x32_bf16 v[132:135], v[60:63], v[28:31], v[132:135]
    s_add_u32 m0, s51, 0
    s_add_u32 s50, s48, 4096
    buffer_load_dwordx4 v2, s[40:43], s48 offen offset:0 nt lds
    buffer_load_dwordx4 v3, s[40:43], s48 offen offset:1024 nt lds
    buffer_load_dwordx4 v2, s[40:43], s48 offen offset:2048 nt lds
    buffer_load_dwordx4 v3, s[40:43], s48 offen offset:3072 nt lds
    s_add_u32 m0, s51, 4096
    s_add_u32 s48, s48, 32768
    buffer_load_dwordx4 v2, s[40:43], s50 offen offset:0 nt lds
    buffer_load_dwordx4 v3, s[40:43], s50 offen offset:1024 nt lds
    buffer_load_dwordx4 v2, s[40:43], s50 offen offset:2048 nt lds
    buffer_load_dwordx4 v3, s[40:43], s50 offen offset:3072 nt lds
    s_waitcnt vmcnt(24)
    ds_read_b64_tr_b16 v[64:65], v8 offset:8192
    ds_read_b64_tr_b16 v[66:67], v8 offset:12288
    ds_read_b64_tr_b16 v[68:69], v9 offset:8192
    ds_read_b64_tr_b16 v[70:71], v9 offset:12288
    ds_read_b64_tr_b16 v[72:73], v10 offset:8192
    ds_read_b64_tr_b16 v[74:75], v10 offset:12288
    ds_read_b64_tr_b16 v[76:77], v11 offset:8192
    ds_read_b64_tr_b16 v[78:79], v11 offset:12288
    ds_read_b64_tr_b16 v[80:81], v12 offset:8192
    ds_read_b64_tr_b16 v[82:83], v12 offset:12288
    ds_read_b64_tr_b16 v[84:85], v13 offset:8192
    ds_read_b64_tr_b16 v[86:87], v13 offset:12288
    ds_read_b64_tr_b16 v[88:89], v14 offset:8192
    ds_read_b64_tr_b16 v[90:91], v14 offset:12288
    ds_read_b64_tr_b16 v[92:93], v15 offset:8192
    ds_read_b64_tr_b16 v[94:95], v15 offset:12288
    v_max3_f32 v142, v128, v129, v130
    v_max3_f32 v142, v142, v131, v132
    v_max3_f32 v142, v142, v133, v134
    v_max3_f32 v142, v142, v135, v140
    v_mov_b32 v143, v142
    s_nop 1
    v_permlane16_swap_b32 v142, v143
    v_max_f32 v142, v142, v143
    v_mov_b32 v143, v142
    s_nop 1
    v_permlane32_swap_b32 v142, v143
    v_max_f32 v142, v142, v143
    v_sub_f32 v144, v140, v142
    v_mul_f32 v144, s52, v144
    v_mov_b32 v140, v142
    v_exp_f32 v144, v144
    v_mul_f32 v145, s52, v142
    v_fma_f32 v128, v128, s52, -v145
    v_fma_f32 v129, v129, s52, -v145
    v_fma_f32 v130, v130, s52, -v145
    v_fma_f32 v131, v131, s52, -v145
    v_fma_f32 v132, v132, s52, -v145
    v_fma_f32 v133, v133, s52, -v145
    v_fma_f32 v134, v134, s52, -v145
    v_fma_f32 v135, v135, s52, -v145
    v_exp_f32 v128, v128
    v_exp_f32 v129, v129
    v_exp_f32 v130, v130
    v_exp_f32 v131, v131
    v_exp_f32 v132, v132
    v_exp_f32 v133, v133
    v_exp_f32 v134, v134
    v_exp_f32 v135, v135
    v_mul_f32 v141, v141, v144
    v_mul_f32 v96, v96, v144
    v_mul_f32 v100, v100, v144
    v_mul_f32 v104, v104, v144
    v_mul_f32 v108, v108, v144
    v_mul_f32 v112, v112, v144
    v_mul_f32 v116, v116, v144
    v_mul_f32 v120, v120, v144
    v_mul_f32 v124, v124, v144
    v_cvt_pk_bf16_f32 v136, v128, v129
    v_cvt_pk_bf16_f32 v137, v130, v131
    v_cvt_pk_bf16_f32 v138, v132, v133
    v_cvt_pk_bf16_f32 v139, v134, v135
    v_add_f32 v142, v128, v129
    v_add_f32 v143, v130, v131
    v_add_f32 v142, v142, v132
    v_add_f32 v143, v143, v133
    v_add_f32 v142, v142, v134
    v_add_f32 v143, v143, v135
    v_add_f32 v142, v142, v143
    v_add_f32 v141, v141, v142
    s_waitcnt lgkmcnt(0)
    v_mfma_f32_16x16x32_bf16 v[96:99], v[136:139], v[64:67], v[96:99]
    v_mfma_f32_16x16x32_bf16 v[100:103], v[136:139], v[68:71], v[100:103]
    v_mfma_f32_16x16x32_bf16 v[104:107], v[136:139], v[72:75], v[104:107]
    v_mfma_f32_16x16x32_bf16 v[108:111], v[136:139], v[76:79], v[108:111]
    v_mfma_f32_16x16x32_bf16 v[112:115], v[136:139], v[80:83], v[112:115]
    v_mfma_f32_16x16x32_bf16 v[116:119], v[136:139], v[84:87], v[116:119]
    v_mfma_f32_16x16x32_bf16 v[120:123], v[136:139], v[88:91], v[120:123]
    v_mfma_f32_16x16x32_bf16 v[124:127], v[136:139], v[92:95], v[124:127]
    s_add_u32 m0, s51, 8192
    s_add_u32 s50, s49, 4096
    buffer_load_dwordx4 v2, s[44:47], s49 offen offset:0 nt lds
    buffer_load_dwordx4 v3, s[44:47], s49 offen offset:1024 nt lds
    buffer_load_dwordx4 v2, s[44:47], s49 offen offset:2048 nt lds
    buffer_load_dwordx4 v3, s[44:47], s49 offen offset:3072 nt lds
    s_add_u32 m0, s51, 12288
    s_add_u32 s49, s49, 32768
    buffer_load_dwordx4 v2, s[44:47], s50 offen offset:0 nt lds
    buffer_load_dwordx4 v3, s[44:47], s50 offen offset:1024 nt lds
    buffer_load_dwordx4 v2, s[44:47], s50 offen offset:2048 nt lds
    buffer_load_dwordx4 v3, s[44:47], s50 offen offset:3072 nt lds
    s_sub_u32 s53, s53, 1
    s_cmp_eq_u32 s53, 0
    s_cbranch_scc1 Ldone_2
    s_waitcnt vmcnt(24)
    ds_read_b128 v[32:35], v4 offset:16384
    ds_read_b128 v[36:39], v5 offset:16384
    ds_read_b128 v[40:43], v6 offset:16384
    ds_read_b128 v[44:47], v7 offset:16384
    ds_read_b128 v[48:51], v4 offset:20480
    ds_read_b128 v[52:55], v5 offset:20480
    ds_read_b128 v[56:59], v6 offset:20480
    ds_read_b128 v[60:63], v7 offset:20480
    s_waitcnt lgkmcnt(3)
    s_waitcnt lgkmcnt(0)
    v_mfma_f32_16x16x32_bf16 v[128:131], v[32:35], v[16:19], 0
    s_waitcnt lgkmcnt(0)
    v_mfma_f32_16x16x32_bf16 v[132:135], v[48:51], v[16:19], 0
    v_mfma_f32_16x16x32_bf16 v[128:131], v[36:39], v[20:23], v[128:131]
    v_mfma_f32_16x16x32_bf16 v[132:135], v[52:55], v[20:23], v[132:135]
    v_mfma_f32_16x16x32_bf16 v[128:131], v[40:43], v[24:27], v[128:131]
    v_mfma_f32_16x16x32_bf16 v[132:135], v[56:59], v[24:27], v[132:135]
    v_mfma_f32_16x16x32_bf16 v[128:131], v[44:47], v[28:31], v[128:131]
    v_mfma_f32_16x16x32_bf16 v[132:135], v[60:63], v[28:31], v[132:135]
    s_add_u32 m0, s51, 16384
    s_add_u32 s50, s48, 4096
    buffer_load_dwordx4 v2, s[40:43], s48 offen offset:0 nt lds
    buffer_load_dwordx4 v3, s[40:43], s48 offen offset:1024 nt lds
    buffer_load_dwordx4 v2, s[40:43], s48 offen offset:2048 nt lds
    buffer_load_dwordx4 v3, s[40:43], s48 offen offset:3072 nt lds
    s_add_u32 m0, s51, 20480
    s_add_u32 s48, s48, 32768
    buffer_load_dwordx4 v2, s[40:43], s50 offen offset:0 nt lds
    buffer_load_dwordx4 v3, s[40:43], s50 offen offset:1024 nt lds
    buffer_load_dwordx4 v2, s[40:43], s50 offen offset:2048 nt lds
    buffer_load_dwordx4 v3, s[40:43], s50 offen offset:3072 nt lds
    s_waitcnt vmcnt(24)
    ds_read_b64_tr_b16 v[64:65], v8 offset:24576
    ds_read_b64_tr_b16 v[66:67], v8 offset:28672
    ds_read_b64_tr_b16 v[68:69], v9 offset:24576
    ds_read_b64_tr_b16 v[70:71], v9 offset:28672
    ds_read_b64_tr_b16 v[72:73], v10 offset:24576
    ds_read_b64_tr_b16 v[74:75], v10 offset:28672
    ds_read_b64_tr_b16 v[76:77], v11 offset:24576
    ds_read_b64_tr_b16 v[78:79], v11 offset:28672
    ds_read_b64_tr_b16 v[80:81], v12 offset:24576
    ds_read_b64_tr_b16 v[82:83], v12 offset:28672
    ds_read_b64_tr_b16 v[84:85], v13 offset:24576
    ds_read_b64_tr_b16 v[86:87], v13 offset:28672
    ds_read_b64_tr_b16 v[88:89], v14 offset:24576
    ds_read_b64_tr_b16 v[90:91], v14 offset:28672
    ds_read_b64_tr_b16 v[92:93], v15 offset:24576
    ds_read_b64_tr_b16 v[94:95], v15 offset:28672
    v_max3_f32 v142, v128, v129, v130
    v_max3_f32 v142, v142, v131, v132
    v_max3_f32 v142, v142, v133, v134
    v_max3_f32 v142, v142, v135, v140
    v_mov_b32 v143, v142
    s_nop 1
    v_permlane16_swap_b32 v142, v143
    v_max_f32 v142, v142, v143
    v_mov_b32 v143, v142
    s_nop 1
    v_permlane32_swap_b32 v142, v143
    v_max_f32 v142, v142, v143
    v_sub_f32 v144, v140, v142
    v_mul_f32 v144, s52, v144
    v_mov_b32 v140, v142
    v_exp_f32 v144, v144
    v_mul_f32 v145, s52, v142
    v_fma_f32 v128, v128, s52, -v145
    v_fma_f32 v129, v129, s52, -v145
    v_fma_f32 v130, v130, s52, -v145
    v_fma_f32 v131, v131, s52, -v145
    v_fma_f32 v132, v132, s52, -v145
    v_fma_f32 v133, v133, s52, -v145
    v_fma_f32 v134, v134, s52, -v145
    v_fma_f32 v135, v135, s52, -v145
    v_exp_f32 v128, v128
    v_exp_f32 v129, v129
    v_exp_f32 v130, v130
    v_exp_f32 v131, v131
    v_exp_f32 v132, v132
    v_exp_f32 v133, v133
    v_exp_f32 v134, v134
    v_exp_f32 v135, v135
    v_mul_f32 v141, v141, v144
    v_mul_f32 v96, v96, v144
    v_mul_f32 v100, v100, v144
    v_mul_f32 v104, v104, v144
    v_mul_f32 v108, v108, v144
    v_mul_f32 v112, v112, v144
    v_mul_f32 v116, v116, v144
    v_mul_f32 v120, v120, v144
    v_mul_f32 v124, v124, v144
    v_cvt_pk_bf16_f32 v136, v128, v129
    v_cvt_pk_bf16_f32 v137, v130, v131
    v_cvt_pk_bf16_f32 v138, v132, v133
    v_cvt_pk_bf16_f32 v139, v134, v135
    v_add_f32 v142, v128, v129
    v_add_f32 v143, v130, v131
    v_add_f32 v142, v142, v132
    v_add_f32 v143, v143, v133
    v_add_f32 v142, v142, v134
    v_add_f32 v143, v143, v135
    v_add_f32 v142, v142, v143
    v_add_f32 v141, v141, v142
    s_waitcnt lgkmcnt(0)
    v_mfma_f32_16x16x32_bf16 v[96:99], v[136:139], v[64:67], v[96:99]
    v_mfma_f32_16x16x32_bf16 v[100:103], v[136:139], v[68:71], v[100:103]
    v_mfma_f32_16x16x32_bf16 v[104:107], v[136:139], v[72:75], v[104:107]
    v_mfma_f32_16x16x32_bf16 v[108:111], v[136:139], v[76:79], v[108:111]
    v_mfma_f32_16x16x32_bf16 v[112:115], v[136:139], v[80:83], v[112:115]
    v_mfma_f32_16x16x32_bf16 v[116:119], v[136:139], v[84:87], v[116:119]
    v_mfma_f32_16x16x32_bf16 v[120:123], v[136:139], v[88:91], v[120:123]
    v_mfma_f32_16x16x32_bf16 v[124:127], v[136:139], v[92:95], v[124:127]
    s_add_u32 m0, s51, 24576
    s_add_u32 s50, s49, 4096
    buffer_load_dwordx4 v2, s[44:47], s49 offen offset:0 nt lds
    buffer_load_dwordx4 v3, s[44:47], s49 offen offset:1024 nt lds
    buffer_load_dwordx4 v2, s[44:47], s49 offen offset:2048 nt lds
    buffer_load_dwordx4 v3, s[44:47], s49 offen offset:3072 nt lds
    s_add_u32 m0, s51, 28672
    s_add_u32 s49, s49, 32768
    buffer_load_dwordx4 v2, s[44:47], s50 offen offset:0 nt lds
    buffer_load_dwordx4 v3, s[44:47], s50 offen offset:1024 nt lds
    buffer_load_dwordx4 v2, s[44:47], s50 offen offset:2048 nt lds
    buffer_load_dwordx4 v3, s[44:47], s50 offen offset:3072 nt lds
    s_sub_u32 s53, s53, 1
    s_cmp_eq_u32 s53, 0
    s_cbranch_scc0 Lloop_1
Ldone_2:
    s_barrier
    s_mov_b32 s53, 4
Lloop_3:
    s_waitcnt vmcnt(24)
    ds_read_b128 v[32:35], v4 offset:0
    ds_read_b128 v[36:39], v5 offset:0
    ds_read_b128 v[40:43], v6 offset:0
    ds_read_b128 v[44:47], v7 offset:0
    ds_read_b128 v[48:51], v4 offset:4096
    ds_read_b128 v[52:55], v5 offset:4096
    ds_read_b128 v[56:59], v6 offset:4096
    ds_read_b128 v[60:63], v7 offset:4096
    s_waitcnt lgkmcnt(3)
    s_waitcnt lgkmcnt(0)
    v_mfma_f32_16x16x32_bf16 v[128:131], v[32:35], v[16:19], 0
    s_waitcnt lgkmcnt(0)
    v_mfma_f32_16x16x32_bf16 v[132:135], v[48:51], v[16:19], 0
    v_mfma_f32_16x16x32_bf16 v[128:131], v[36:39], v[20:23], v[128:131]
    v_mfma_f32_16x16x32_bf16 v[132:135], v[52:55], v[20:23], v[132:135]
    v_mfma_f32_16x16x32_bf16 v[128:131], v[40:43], v[24:27], v[128:131]
    v_mfma_f32_16x16x32_bf16 v[132:135], v[56:59], v[24:27], v[132:135]
    v_mfma_f32_16x16x32_bf16 v[128:131], v[44:47], v[28:31], v[128:131]
    v_mfma_f32_16x16x32_bf16 v[132:135], v[60:63], v[28:31], v[132:135]
    s_add_u32 m0, s51, 0
    s_add_u32 s50, s48, 4096
    buffer_load_dwordx4 v2, s[40:43], s48 offen offset:0 nt lds
    buffer_load_dwordx4 v3, s[40:43], s48 offen offset:1024 nt lds
    buffer_load_dwordx4 v2, s[40:43], s48 offen offset:2048 nt lds
    buffer_load_dwordx4 v3, s[40:43], s48 offen offset:3072 nt lds
    s_add_u32 m0, s51, 4096
    s_add_u32 s48, s48, 32768
    buffer_load_dwordx4 v2, s[40:43], s50 offen offset:0 nt lds
    buffer_load_dwordx4 v3, s[40:43], s50 offen offset:1024 nt lds
    buffer_load_dwordx4 v2, s[40:43], s50 offen offset:2048 nt lds
    buffer_load_dwordx4 v3, s[40:43], s50 offen offset:3072 nt lds
    s_waitcnt vmcnt(24)
    ds_read_b64_tr_b16 v[64:65], v8 offset:8192
    ds_read_b64_tr_b16 v[66:67], v8 offset:12288
    ds_read_b64_tr_b16 v[68:69], v9 offset:8192
    ds_read_b64_tr_b16 v[70:71], v9 offset:12288
    ds_read_b64_tr_b16 v[72:73], v10 offset:8192
    ds_read_b64_tr_b16 v[74:75], v10 offset:12288
    ds_read_b64_tr_b16 v[76:77], v11 offset:8192
    ds_read_b64_tr_b16 v[78:79], v11 offset:12288
    ds_read_b64_tr_b16 v[80:81], v12 offset:8192
    ds_read_b64_tr_b16 v[82:83], v12 offset:12288
    ds_read_b64_tr_b16 v[84:85], v13 offset:8192
    ds_read_b64_tr_b16 v[86:87], v13 offset:12288
    ds_read_b64_tr_b16 v[88:89], v14 offset:8192
    ds_read_b64_tr_b16 v[90:91], v14 offset:12288
    ds_read_b64_tr_b16 v[92:93], v15 offset:8192
    ds_read_b64_tr_b16 v[94:95], v15 offset:12288
    v_max3_f32 v142, v128, v129, v130
    v_max3_f32 v142, v142, v131, v132
    v_max3_f32 v142, v142, v133, v134
    v_max3_f32 v142, v142, v135, v140
    v_mov_b32 v143, v142
    s_nop 1
    v_permlane16_swap_b32 v142, v143
    v_max_f32 v142, v142, v143
    v_mov_b32 v143, v142
    s_nop 1
    v_permlane32_swap_b32 v142, v143
    v_max_f32 v142, v142, v143
    v_sub_f32 v144, v140, v142
    v_mul_f32 v144, s52, v144
    v_mov_b32 v140, v142
    v_exp_f32 v144, v144
    v_mul_f32 v145, s52, v142
    v_fma_f32 v128, v128, s52, -v145
    v_fma_f32 v129, v129, s52, -v145
    v_fma_f32 v130, v130, s52, -v145
    v_fma_f32 v131, v131, s52, -v145
    v_fma_f32 v132, v132, s52, -v145
    v_fma_f32 v133, v133, s52, -v145
    v_fma_f32 v134, v134, s52, -v145
    v_fma_f32 v135, v135, s52, -v145
    v_exp_f32 v128, v128
    v_exp_f32 v129, v129
    v_exp_f32 v130, v130
    v_exp_f32 v131, v131
    v_exp_f32 v132, v132
    v_exp_f32 v133, v133
    v_exp_f32 v134, v134
    v_exp_f32 v135, v135
    v_mul_f32 v141, v141, v144
    v_mul_f32 v96, v96, v144
    v_mul_f32 v100, v100, v144
    v_mul_f32 v104, v104, v144
    v_mul_f32 v108, v108, v144
    v_mul_f32 v112, v112, v144
    v_mul_f32 v116, v116, v144
    v_mul_f32 v120, v120, v144
    v_mul_f32 v124, v124, v144
    v_cvt_pk_bf16_f32 v136, v128, v129
    v_cvt_pk_bf16_f32 v137, v130, v131
    v_cvt_pk_bf16_f32 v138, v132, v133
    v_cvt_pk_bf16_f32 v139, v134, v135
    v_add_f32 v142, v128, v129
    v_add_f32 v143, v130, v131
    v_add_f32 v142, v142, v132
    v_add_f32 v143, v143, v133
    v_add_f32 v142, v142, v134
    v_add_f32 v143, v143, v135
    v_add_f32 v142, v142, v143
    v_add_f32 v141, v141, v142
    s_waitcnt lgkmcnt(0)
    v_mfma_f32_16x16x32_bf16 v[96:99], v[136:139], v[64:67], v[96:99]
    v_mfma_f32_16x16x32_bf16 v[100:103], v[136:139], v[68:71], v[100:103]
    v_mfma_f32_16x16x32_bf16 v[104:107], v[136:139], v[72:75], v[104:107]
    v_mfma_f32_16x16x32_bf16 v[108:111], v[136:139], v[76:79], v[108:111]
    v_mfma_f32_16x16x32_bf16 v[112:115], v[136:139], v[80:83], v[112:115]
    v_mfma_f32_16x16x32_bf16 v[116:119], v[136:139], v[84:87], v[116:119]
    v_mfma_f32_16x16x32_bf16 v[120:123], v[136:139], v[88:91], v[120:123]
    v_mfma_f32_16x16x32_bf16 v[124:127], v[136:139], v[92:95], v[124:127]
    s_add_u32 m0, s51, 8192
    s_add_u32 s50, s49, 4096
    buffer_load_dwordx4 v2, s[44:47], s49 offen offset:0 nt lds
    buffer_load_dwordx4 v3, s[44:47], s49 offen offset:1024 nt lds
    buffer_load_dwordx4 v2, s[44:47], s49 offen offset:2048 nt lds
    buffer_load_dwordx4 v3, s[44:47], s49 offen offset:3072 nt lds
    s_add_u32 m0, s51, 12288
    s_add_u32 s49, s49, 32768
    buffer_load_dwordx4 v2, s[44:47], s50 offen offset:0 nt lds
    buffer_load_dwordx4 v3, s[44:47], s50 offen offset:1024 nt lds
    buffer_load_dwordx4 v2, s[44:47], s50 offen offset:2048 nt lds
    buffer_load_dwordx4 v3, s[44:47], s50 offen offset:3072 nt lds
    s_sub_u32 s53, s53, 1
    s_cmp_eq_u32 s53, 0
    s_cbranch_scc1 Ldone_4
    s_waitcnt vmcnt(24)
    ds_read_b128 v[32:35], v4 offset:16384
    ds_read_b128 v[36:39], v5 offset:16384
    ds_read_b128 v[40:43], v6 offset:16384
    ds_read_b128 v[44:47], v7 offset:16384
    ds_read_b128 v[48:51], v4 offset:20480
    ds_read_b128 v[52:55], v5 offset:20480
    ds_read_b128 v[56:59], v6 offset:20480
    ds_read_b128 v[60:63], v7 offset:20480
    s_waitcnt lgkmcnt(3)
    s_waitcnt lgkmcnt(0)
    v_mfma_f32_16x16x32_bf16 v[128:131], v[32:35], v[16:19], 0
    s_waitcnt lgkmcnt(0)
    v_mfma_f32_16x16x32_bf16 v[132:135], v[48:51], v[16:19], 0
    v_mfma_f32_16x16x32_bf16 v[128:131], v[36:39], v[20:23], v[128:131]
    v_mfma_f32_16x16x32_bf16 v[132:135], v[52:55], v[20:23], v[132:135]
    v_mfma_f32_16x16x32_bf16 v[128:131], v[40:43], v[24:27], v[128:131]
    v_mfma_f32_16x16x32_bf16 v[132:135], v[56:59], v[24:27], v[132:135]
    v_mfma_f32_16x16x32_bf16 v[128:131], v[44:47], v[28:31], v[128:131]
    v_mfma_f32_16x16x32_bf16 v[132:135], v[60:63], v[28:31], v[132:135]
    s_add_u32 m0, s51, 16384
    s_add_u32 s50, s48, 4096
    buffer_load_dwordx4 v2, s[40:43], s48 offen offset:0 nt lds
    buffer_load_dwordx4 v3, s[40:43], s48 offen offset:1024 nt lds
    buffer_load_dwordx4 v2, s[40:43], s48 offen offset:2048 nt lds
    buffer_load_dwordx4 v3, s[40:43], s48 offen offset:3072 nt lds
    s_add_u32 m0, s51, 20480
    s_add_u32 s48, s48, 32768
    buffer_load_dwordx4 v2, s[40:43], s50 offen offset:0 nt lds
    buffer_load_dwordx4 v3, s[40:43], s50 offen offset:1024 nt lds
    buffer_load_dwordx4 v2, s[40:43], s50 offen offset:2048 nt lds
    buffer_load_dwordx4 v3, s[40:43], s50 offen offset:3072 nt lds
    s_waitcnt vmcnt(24)
    ds_read_b64_tr_b16 v[64:65], v8 offset:24576
    ds_read_b64_tr_b16 v[66:67], v8 offset:28672
    ds_read_b64_tr_b16 v[68:69], v9 offset:24576
    ds_read_b64_tr_b16 v[70:71], v9 offset:28672
    ds_read_b64_tr_b16 v[72:73], v10 offset:24576
    ds_read_b64_tr_b16 v[74:75], v10 offset:28672
    ds_read_b64_tr_b16 v[76:77], v11 offset:24576
    ds_read_b64_tr_b16 v[78:79], v11 offset:28672
    ds_read_b64_tr_b16 v[80:81], v12 offset:24576
    ds_read_b64_tr_b16 v[82:83], v12 offset:28672
    ds_read_b64_tr_b16 v[84:85], v13 offset:24576
    ds_read_b64_tr_b16 v[86:87], v13 offset:28672
    ds_read_b64_tr_b16 v[88:89], v14 offset:24576
    ds_read_b64_tr_b16 v[90:91], v14 offset:28672
    ds_read_b64_tr_b16 v[92:93], v15 offset:24576
    ds_read_b64_tr_b16 v[94:95], v15 offset:28672
    v_max3_f32 v142, v128, v129, v130
    v_max3_f32 v142, v142, v131, v132
    v_max3_f32 v142, v142, v133, v134
    v_max3_f32 v142, v142, v135, v140
    v_mov_b32 v143, v142
    s_nop 1
    v_permlane16_swap_b32 v142, v143
    v_max_f32 v142, v142, v143
    v_mov_b32 v143, v142
    s_nop 1
    v_permlane32_swap_b32 v142, v143
    v_max_f32 v142, v142, v143
    v_sub_f32 v144, v140, v142
    v_mul_f32 v144, s52, v144
    v_mov_b32 v140, v142
    v_exp_f32 v144, v144
    v_mul_f32 v145, s52, v142
    v_fma_f32 v128, v128, s52, -v145
    v_fma_f32 v129, v129, s52, -v145
    v_fma_f32 v130, v130, s52, -v145
    v_fma_f32 v131, v131, s52, -v145
    v_fma_f32 v132, v132, s52, -v145
    v_fma_f32 v133, v133, s52, -v145
    v_fma_f32 v134, v134, s52, -v145
    v_fma_f32 v135, v135, s52, -v145
    v_exp_f32 v128, v128
    v_exp_f32 v129, v129
    v_exp_f32 v130, v130
    v_exp_f32 v131, v131
    v_exp_f32 v132, v132
    v_exp_f32 v133, v133
    v_exp_f32 v134, v134
    v_exp_f32 v135, v135
    v_mul_f32 v141, v141, v144
    v_mul_f32 v96, v96, v144
    v_mul_f32 v100, v100, v144
    v_mul_f32 v104, v104, v144
    v_mul_f32 v108, v108, v144
    v_mul_f32 v112, v112, v144
    v_mul_f32 v116, v116, v144
    v_mul_f32 v120, v120, v144
    v_mul_f32 v124, v124, v144
    v_cvt_pk_bf16_f32 v136, v128, v129
    v_cvt_pk_bf16_f32 v137, v130, v131
    v_cvt_pk_bf16_f32 v138, v132, v133
    v_cvt_pk_bf16_f32 v139, v134, v135
    v_add_f32 v142, v128, v129
    v_add_f32 v143, v130, v131
    v_add_f32 v142, v142, v132
    v_add_f32 v143, v143, v133
    v_add_f32 v142, v142, v134
    v_add_f32 v143, v143, v135
    v_add_f32 v142, v142, v143
    v_add_f32 v141, v141, v142
    s_waitcnt lgkmcnt(0)
    v_mfma_f32_16x16x32_bf16 v[96:99], v[136:139], v[64:67], v[96:99]
    v_mfma_f32_16x16x32_bf16 v[100:103], v[136:139], v[68:71], v[100:103]
    v_mfma_f32_16x16x32_bf16 v[104:107], v[136:139], v[72:75], v[104:107]
    v_mfma_f32_16x16x32_bf16 v[108:111], v[136:139], v[76:79], v[108:111]
    v_mfma_f32_16x16x32_bf16 v[112:115], v[136:139], v[80:83], v[112:115]
    v_mfma_f32_16x16x32_bf16 v[116:119], v[136:139], v[84:87], v[116:119]
    v_mfma_f32_16x16x32_bf16 v[120:123], v[136:139], v[88:91], v[120:123]
    v_mfma_f32_16x16x32_bf16 v[124:127], v[136:139], v[92:95], v[124:127]
    s_add_u32 m0, s51, 24576
    s_add_u32 s50, s49, 4096
    buffer_load_dwordx4 v2, s[44:47], s49 offen offset:0 nt lds
    buffer_load_dwordx4 v3, s[44:47], s49 offen offset:1024 nt lds
    buffer_load_dwordx4 v2, s[44:47], s49 offen offset:2048 nt lds
    buffer_load_dwordx4 v3, s[44:47], s49 offen offset:3072 nt lds
    s_add_u32 m0, s51, 28672
    s_add_u32 s49, s49, 32768
    buffer_load_dwordx4 v2, s[44:47], s50 offen offset:0 nt lds
    buffer_load_dwordx4 v3, s[44:47], s50 offen offset:1024 nt lds
    buffer_load_dwordx4 v2, s[44:47], s50 offen offset:2048 nt lds
    buffer_load_dwordx4 v3, s[44:47], s50 offen offset:3072 nt lds
    s_sub_u32 s53, s53, 1
    s_cmp_eq_u32 s53, 0
    s_cbranch_scc0 Lloop_3
Ldone_4:
    s_and_b32 s34, s2, 7
    s_mul_i32 s34, s34, 40
    s_add_u32 s34, s34, s3
    s_lshl_b32 s34, s34, 13
    s_add_u32 s48, s34, 0x8000000
    s_mov_b32 s49, s48
    s_waitcnt vmcnt(24)
    ds_read_b128 v[32:35], v4 offset:0
    ds_read_b128 v[36:39], v5 offset:0
    ds_read_b128 v[40:43], v6 offset:0
    ds_read_b128 v[44:47], v7 offset:0
    ds_read_b128 v[48:51], v4 offset:4096
    ds_read_b128 v[52:55], v5 offset:4096
    ds_read_b128 v[56:59], v6 offset:4096
    ds_read_b128 v[60:63], v7 offset:4096
    s_waitcnt lgkmcnt(3)
    s_waitcnt lgkmcnt(0)
    v_mfma_f32_16x16x32_bf16 v[128:131], v[32:35], v[16:19], 0
    s_waitcnt lgkmcnt(0)
    v_mfma_f32_16x16x32_bf16 v[132:135], v[48:51], v[16:19], 0
    v_mfma_f32_16x16x32_bf16 v[128:131], v[36:39], v[20:23], v[128:131]
    v_mfma_f32_16x16x32_bf16 v[132:135], v[52:55], v[20:23], v[132:135]
    v_mfma_f32_16x16x32_bf16 v[128:131], v[40:43], v[24:27], v[128:131]
    v_mfma_f32_16x16x32_bf16 v[132:135], v[56:59], v[24:27], v[132:135]
    v_mfma_f32_16x16x32_bf16 v[128:131], v[44:47], v[28:31], v[128:131]
    v_mfma_f32_16x16x32_bf16 v[132:135], v[60:63], v[28:31], v[132:135]
    s_add_u32 m0, s51, 0
    s_add_u32 s50, s48, 4096
    buffer_load_dwordx4 v2, s[40:43], s48 offen offset:0 nt lds
    buffer_load_dwordx4 v3, s[40:43], s48 offen offset:1024 nt lds
    buffer_load_dwordx4 v2, s[40:43], s48 offen offset:2048 nt lds
    buffer_load_dwordx4 v3, s[40:43], s48 offen offset:3072 nt lds
    s_add_u32 m0, s51, 4096
    s_add_u32 s48, s48, 32768
    buffer_load_dwordx4 v2, s[40:43], s50 offen offset:0 nt lds
    buffer_load_dwordx4 v3, s[40:43], s50 offen offset:1024 nt lds
    buffer_load_dwordx4 v2, s[40:43], s50 offen offset:2048 nt lds
    buffer_load_dwordx4 v3, s[40:43], s50 offen offset:3072 nt lds
    s_waitcnt vmcnt(24)
    ds_read_b64_tr_b16 v[64:65], v8 offset:8192
    ds_read_b64_tr_b16 v[66:67], v8 offset:12288
    ds_read_b64_tr_b16 v[68:69], v9 offset:8192
    ds_read_b64_tr_b16 v[70:71], v9 offset:12288
    ds_read_b64_tr_b16 v[72:73], v10 offset:8192
    ds_read_b64_tr_b16 v[74:75], v10 offset:12288
    ds_read_b64_tr_b16 v[76:77], v11 offset:8192
    ds_read_b64_tr_b16 v[78:79], v11 offset:12288
    ds_read_b64_tr_b16 v[80:81], v12 offset:8192
    ds_read_b64_tr_b16 v[82:83], v12 offset:12288
    ds_read_b64_tr_b16 v[84:85], v13 offset:8192
    ds_read_b64_tr_b16 v[86:87], v13 offset:12288
    ds_read_b64_tr_b16 v[88:89], v14 offset:8192
    ds_read_b64_tr_b16 v[90:91], v14 offset:12288
    ds_read_b64_tr_b16 v[92:93], v15 offset:8192
    ds_read_b64_tr_b16 v[94:95], v15 offset:12288
    v_max3_f32 v142, v128, v129, v130
    v_max3_f32 v142, v142, v131, v132
    v_max3_f32 v142, v142, v133, v134
    v_max3_f32 v142, v142, v135, v140
    v_mov_b32 v143, v142
    s_nop 1
    v_permlane16_swap_b32 v142, v143
    v_max_f32 v142, v142, v143
    v_mov_b32 v143, v142
    s_nop 1
    v_permlane32_swap_b32 v142, v143
    v_max_f32 v142, v142, v143
    v_sub_f32 v144, v140, v142
    v_mul_f32 v144, s52, v144
    v_mov_b32 v140, v142
    v_exp_f32 v144, v144
    v_mul_f32 v145, s52, v142
    v_fma_f32 v128, v128, s52, -v145
    v_fma_f32 v129, v129, s52, -v145
    v_fma_f32 v130, v130, s52, -v145
    v_fma_f32 v131, v131, s52, -v145
    v_fma_f32 v132, v132, s52, -v145
    v_fma_f32 v133, v133, s52, -v145
    v_fma_f32 v134, v134, s52, -v145
    v_fma_f32 v135, v135, s52, -v145
    v_exp_f32 v128, v128
    v_exp_f32 v129, v129
    v_exp_f32 v130, v130
    v_exp_f32 v131, v131
    v_exp_f32 v132, v132
    v_exp_f32 v133, v133
    v_exp_f32 v134, v134
    v_exp_f32 v135, v135
    v_mul_f32 v141, v141, v144
    v_mul_f32 v96, v96, v144
    v_mul_f32 v100, v100, v144
    v_mul_f32 v104, v104, v144
    v_mul_f32 v108, v108, v144
    v_mul_f32 v112, v112, v144
    v_mul_f32 v116, v116, v144
    v_mul_f32 v120, v120, v144
    v_mul_f32 v124, v124, v144
    v_cvt_pk_bf16_f32 v136, v128, v129
    v_cvt_pk_bf16_f32 v137, v130, v131
    v_cvt_pk_bf16_f32 v138, v132, v133
    v_cvt_pk_bf16_f32 v139, v134, v135
    v_add_f32 v142, v128, v129
    v_add_f32 v143, v130, v131
    v_add_f32 v142, v142, v132
    v_add_f32 v143, v143, v133
    v_add_f32 v142, v142, v134
    v_add_f32 v143, v143, v135
    v_add_f32 v142, v142, v143
    v_add_f32 v141, v141, v142
    s_waitcnt lgkmcnt(0)
    v_mfma_f32_16x16x32_bf16 v[96:99], v[136:139], v[64:67], v[96:99]
    v_mfma_f32_16x16x32_bf16 v[100:103], v[136:139], v[68:71], v[100:103]
    v_mfma_f32_16x16x32_bf16 v[104:107], v[136:139], v[72:75], v[104:107]
    v_mfma_f32_16x16x32_bf16 v[108:111], v[136:139], v[76:79], v[108:111]
    v_mfma_f32_16x16x32_bf16 v[112:115], v[136:139], v[80:83], v[112:115]
    v_mfma_f32_16x16x32_bf16 v[116:119], v[136:139], v[84:87], v[116:119]
    v_mfma_f32_16x16x32_bf16 v[120:123], v[136:139], v[88:91], v[120:123]
    v_mfma_f32_16x16x32_bf16 v[124:127], v[136:139], v[92:95], v[124:127]
    s_add_u32 m0, s51, 8192
    s_add_u32 s50, s49, 4096
    buffer_load_dwordx4 v2, s[44:47], s49 offen offset:0 nt lds
    buffer_load_dwordx4 v3, s[44:47], s49 offen offset:1024 nt lds
    buffer_load_dwordx4 v2, s[44:47], s49 offen offset:2048 nt lds
    buffer_load_dwordx4 v3, s[44:47], s49 offen offset:3072 nt lds
    s_add_u32 m0, s51, 12288
    s_add_u32 s49, s49, 32768
    buffer_load_dwordx4 v2, s[44:47], s50 offen offset:0 nt lds
    buffer_load_dwordx4 v3, s[44:47], s50 offen offset:1024 nt lds
    buffer_load_dwordx4 v2, s[44:47], s50 offen offset:2048 nt lds
    buffer_load_dwordx4 v3, s[44:47], s50 offen offset:3072 nt lds
    s_waitcnt vmcnt(24)
    ds_read_b128 v[32:35], v4 offset:16384
    ds_read_b128 v[36:39], v5 offset:16384
    ds_read_b128 v[40:43], v6 offset:16384
    ds_read_b128 v[44:47], v7 offset:16384
    ds_read_b128 v[48:51], v4 offset:20480
    ds_read_b128 v[52:55], v5 offset:20480
    ds_read_b128 v[56:59], v6 offset:20480
    ds_read_b128 v[60:63], v7 offset:20480
    s_waitcnt lgkmcnt(3)
    s_waitcnt lgkmcnt(0)
    v_mfma_f32_16x16x32_bf16 v[128:131], v[32:35], v[16:19], 0
    s_waitcnt lgkmcnt(0)
    v_mfma_f32_16x16x32_bf16 v[132:135], v[48:51], v[16:19], 0
    v_mfma_f32_16x16x32_bf16 v[128:131], v[36:39], v[20:23], v[128:131]
    v_mfma_f32_16x16x32_bf16 v[132:135], v[52:55], v[20:23], v[132:135]
    v_mfma_f32_16x16x32_bf16 v[128:131], v[40:43], v[24:27], v[128:131]
    v_mfma_f32_16x16x32_bf16 v[132:135], v[56:59], v[24:27], v[132:135]
    v_mfma_f32_16x16x32_bf16 v[128:131], v[44:47], v[28:31], v[128:131]
    v_mfma_f32_16x16x32_bf16 v[132:135], v[60:63], v[28:31], v[132:135]
    s_add_u32 m0, s51, 16384
    s_add_u32 s50, s48, 4096
    buffer_load_dwordx4 v2, s[40:43], s48 offen offset:0 nt lds
    buffer_load_dwordx4 v3, s[40:43], s48 offen offset:1024 nt lds
    buffer_load_dwordx4 v2, s[40:43], s48 offen offset:2048 nt lds
    buffer_load_dwordx4 v3, s[40:43], s48 offen offset:3072 nt lds
    s_add_u32 m0, s51, 20480
    s_add_u32 s48, s48, 32768
    buffer_load_dwordx4 v2, s[40:43], s50 offen offset:0 nt lds
    buffer_load_dwordx4 v3, s[40:43], s50 offen offset:1024 nt lds
    buffer_load_dwordx4 v2, s[40:43], s50 offen offset:2048 nt lds
    buffer_load_dwordx4 v3, s[40:43], s50 offen offset:3072 nt lds
    s_waitcnt vmcnt(24)
    ds_read_b64_tr_b16 v[64:65], v8 offset:24576
    ds_read_b64_tr_b16 v[66:67], v8 offset:28672
    ds_read_b64_tr_b16 v[68:69], v9 offset:24576
    ds_read_b64_tr_b16 v[70:71], v9 offset:28672
    ds_read_b64_tr_b16 v[72:73], v10 offset:24576
    ds_read_b64_tr_b16 v[74:75], v10 offset:28672
    ds_read_b64_tr_b16 v[76:77], v11 offset:24576
    ds_read_b64_tr_b16 v[78:79], v11 offset:28672
    ds_read_b64_tr_b16 v[80:81], v12 offset:24576
    ds_read_b64_tr_b16 v[82:83], v12 offset:28672
    ds_read_b64_tr_b16 v[84:85], v13 offset:24576
    ds_read_b64_tr_b16 v[86:87], v13 offset:28672
    ds_read_b64_tr_b16 v[88:89], v14 offset:24576
    ds_read_b64_tr_b16 v[90:91], v14 offset:28672
    ds_read_b64_tr_b16 v[92:93], v15 offset:24576
    ds_read_b64_tr_b16 v[94:95], v15 offset:28672
    v_max3_f32 v142, v128, v129, v130
    v_max3_f32 v142, v142, v131, v132
    v_max3_f32 v142, v142, v133, v134
    v_max3_f32 v142, v142, v135, v140
    v_mov_b32 v143, v142
    s_nop 1
    v_permlane16_swap_b32 v142, v143
    v_max_f32 v142, v142, v143
    v_mov_b32 v143, v142
    s_nop 1
    v_permlane32_swap_b32 v142, v143
    v_max_f32 v142, v142, v143
    v_sub_f32 v144, v140, v142
    v_mul_f32 v144, s52, v144
    v_mov_b32 v140, v142
    v_exp_f32 v144, v144
    v_mul_f32 v145, s52, v142
    v_fma_f32 v128, v128, s52, -v145
    v_fma_f32 v129, v129, s52, -v145
    v_fma_f32 v130, v130, s52, -v145
    v_fma_f32 v131, v131, s52, -v145
    v_fma_f32 v132, v132, s52, -v145
    v_fma_f32 v133, v133, s52, -v145
    v_fma_f32 v134, v134, s52, -v145
    v_fma_f32 v135, v135, s52, -v145
    v_exp_f32 v128, v128
    v_exp_f32 v129, v129
    v_exp_f32 v130, v130
    v_exp_f32 v131, v131
    v_exp_f32 v132, v132
    v_exp_f32 v133, v133
    v_exp_f32 v134, v134
    v_exp_f32 v135, v135
    v_mul_f32 v141, v141, v144
    v_mul_f32 v96, v96, v144
    v_mul_f32 v100, v100, v144
    v_mul_f32 v104, v104, v144
    v_mul_f32 v108, v108, v144
    v_mul_f32 v112, v112, v144
    v_mul_f32 v116, v116, v144
    v_mul_f32 v120, v120, v144
    v_mul_f32 v124, v124, v144
    v_cvt_pk_bf16_f32 v136, v128, v129
    v_cvt_pk_bf16_f32 v137, v130, v131
    v_cvt_pk_bf16_f32 v138, v132, v133
    v_cvt_pk_bf16_f32 v139, v134, v135
    v_add_f32 v142, v128, v129
    v_add_f32 v143, v130, v131
    v_add_f32 v142, v142, v132
    v_add_f32 v143, v143, v133
    v_add_f32 v142, v142, v134
    v_add_f32 v143, v143, v135
    v_add_f32 v142, v142, v143
    v_add_f32 v141, v141, v142
    s_waitcnt lgkmcnt(0)
    v_mfma_f32_16x16x32_bf16 v[96:99], v[136:139], v[64:67], v[96:99]
    v_mfma_f32_16x16x32_bf16 v[100:103], v[136:139], v[68:71], v[100:103]
    v_mfma_f32_16x16x32_bf16 v[104:107], v[136:139], v[72:75], v[104:107]
    v_mfma_f32_16x16x32_bf16 v[108:111], v[136:139], v[76:79], v[108:111]
    v_mfma_f32_16x16x32_bf16 v[112:115], v[136:139], v[80:83], v[112:115]
    v_mfma_f32_16x16x32_bf16 v[116:119], v[136:139], v[84:87], v[116:119]
    v_mfma_f32_16x16x32_bf16 v[120:123], v[136:139], v[88:91], v[120:123]
    v_mfma_f32_16x16x32_bf16 v[124:127], v[136:139], v[92:95], v[124:127]
    s_add_u32 m0, s51, 24576
    s_add_u32 s50, s49, 4096
    buffer_load_dwordx4 v2, s[44:47], s49 offen offset:0 nt lds
    buffer_load_dwordx4 v3, s[44:47], s49 offen offset:1024 nt lds
    buffer_load_dwordx4 v2, s[44:47], s49 offen offset:2048 nt lds
    buffer_load_dwordx4 v3, s[44:47], s49 offen offset:3072 nt lds
    s_add_u32 m0, s51, 28672
    s_add_u32 s49, s49, 32768
    buffer_load_dwordx4 v2, s[44:47], s50 offen offset:0 nt lds
    buffer_load_dwordx4 v3, s[44:47], s50 offen offset:1024 nt lds
    buffer_load_dwordx4 v2, s[44:47], s50 offen offset:2048 nt lds
    buffer_load_dwordx4 v3, s[44:47], s50 offen offset:3072 nt lds
    s_nop 7
    s_nop 7
    v_mov_b32 v143, v141
    s_nop 1
    v_permlane16_swap_b32 v141, v143
    v_add_f32 v141, v141, v143
    v_mov_b32 v143, v141
    s_nop 1
    v_permlane32_swap_b32 v141, v143
    v_add_f32 v141, v141, v143
    s_mov_b64 exec, 0xffff
    ds_write_b32 v147, v96 offset:0
    ds_write_b32 v147, v100 offset:64
    ds_write_b32 v147, v104 offset:128
    ds_write_b32 v147, v108 offset:192
    ds_write_b32 v147, v112 offset:256
    ds_write_b32 v147, v116 offset:320
    ds_write_b32 v147, v120 offset:384
    ds_write_b32 v147, v124 offset:448
    s_mov_b64 exec, 1
    ds_write_b32 v147, v140 offset:512
    ds_write_b32 v147, v141 offset:516
    s_mov_b64 exec, -1
    v_mov_b32 v140, 0xff800000
    v_mov_b32 v141, 0
    v_mov_b32 v96, 0
    v_mov_b32 v97, 0
    v_mov_b32 v98, 0
    v_mov_b32 v99, 0
    v_mov_b32 v100, 0
    v_mov_b32 v101, 0
    v_mov_b32 v102, 0
    v_mov_b32 v103, 0
    v_mov_b32 v104, 0
    v_mov_b32 v105, 0
    v_mov_b32 v106, 0
    v_mov_b32 v107, 0
    v_mov_b32 v108, 0
    v_mov_b32 v109, 0
    v_mov_b32 v110, 0
    v_mov_b32 v111, 0
    v_mov_b32 v112, 0
    v_mov_b32 v113, 0
    v_mov_b32 v114, 0
    v_mov_b32 v115, 0
    v_mov_b32 v116, 0
    v_mov_b32 v117, 0
    v_mov_b32 v118, 0
    v_mov_b32 v119, 0
    v_mov_b32 v120, 0
    v_mov_b32 v121, 0
    v_mov_b32 v122, 0
    v_mov_b32 v123, 0
    v_mov_b32 v124, 0
    v_mov_b32 v125, 0
    v_mov_b32 v126, 0
    v_mov_b32 v127, 0
    ds_read_b128 v[16:19], v146 offset:256
    ds_read_b128 v[20:23], v146 offset:320
    ds_read_b128 v[24:27], v146 offset:384
    ds_read_b128 v[28:31], v146 offset:448
    s_waitcnt lgkmcnt(0)
    s_mov_b32 s53, 6
Lloop_5:
    s_waitcnt vmcnt(24)
    ds_read_b128 v[32:35], v4 offset:0
    ds_read_b128 v[36:39], v5 offset:0
    ds_read_b128 v[40:43], v6 offset:0
    ds_read_b128 v[44:47], v7 offset:0
    ds_read_b128 v[48:51], v4 offset:4096
    ds_read_b128 v[52:55], v5 offset:4096
    ds_read_b128 v[56:59], v6 offset:4096
    ds_read_b128 v[60:63], v7 offset:4096
    s_waitcnt lgkmcnt(3)
    s_waitcnt lgkmcnt(0)
    v_mfma_f32_16x16x32_bf16 v[128:131], v[32:35], v[16:19], 0
    s_waitcnt lgkmcnt(0)
    v_mfma_f32_16x16x32_bf16 v[132:135], v[48:51], v[16:19], 0
    v_mfma_f32_16x16x32_bf16 v[128:131], v[36:39], v[20:23], v[128:131]
    v_mfma_f32_16x16x32_bf16 v[132:135], v[52:55], v[20:23], v[132:135]
    v_mfma_f32_16x16x32_bf16 v[128:131], v[40:43], v[24:27], v[128:131]
    v_mfma_f32_16x16x32_bf16 v[132:135], v[56:59], v[24:27], v[132:135]
    v_mfma_f32_16x16x32_bf16 v[128:131], v[44:47], v[28:31], v[128:131]
    v_mfma_f32_16x16x32_bf16 v[132:135], v[60:63], v[28:31], v[132:135]
    s_add_u32 m0, s51, 0
    s_add_u32 s50, s48, 4096
    buffer_load_dwordx4 v2, s[40:43], s48 offen offset:0 nt lds
    buffer_load_dwordx4 v3, s[40:43], s48 offen offset:1024 nt lds
    buffer_load_dwordx4 v2, s[40:43], s48 offen offset:2048 nt lds
    buffer_load_dwordx4 v3, s[40:43], s48 offen offset:3072 nt lds
    s_add_u32 m0, s51, 4096
    s_add_u32 s48, s48, 32768
    buffer_load_dwordx4 v2, s[40:43], s50 offen offset:0 nt lds
    buffer_load_dwordx4 v3, s[40:43], s50 offen offset:1024 nt lds
    buffer_load_dwordx4 v2, s[40:43], s50 offen offset:2048 nt lds
    buffer_load_dwordx4 v3, s[40:43], s50 offen offset:3072 nt lds
    s_waitcnt vmcnt(24)
    ds_read_b64_tr_b16 v[64:65], v8 offset:8192
    ds_read_b64_tr_b16 v[66:67], v8 offset:12288
    ds_read_b64_tr_b16 v[68:69], v9 offset:8192
    ds_read_b64_tr_b16 v[70:71], v9 offset:12288
    ds_read_b64_tr_b16 v[72:73], v10 offset:8192
    ds_read_b64_tr_b16 v[74:75], v10 offset:12288
    ds_read_b64_tr_b16 v[76:77], v11 offset:8192
    ds_read_b64_tr_b16 v[78:79], v11 offset:12288
    ds_read_b64_tr_b16 v[80:81], v12 offset:8192
    ds_read_b64_tr_b16 v[82:83], v12 offset:12288
    ds_read_b64_tr_b16 v[84:85], v13 offset:8192
    ds_read_b64_tr_b16 v[86:87], v13 offset:12288
    ds_read_b64_tr_b16 v[88:89], v14 offset:8192
    ds_read_b64_tr_b16 v[90:91], v14 offset:12288
    ds_read_b64_tr_b16 v[92:93], v15 offset:8192
    ds_read_b64_tr_b16 v[94:95], v15 offset:12288
    v_max3_f32 v142, v128, v129, v130
    v_max3_f32 v142, v142, v131, v132
    v_max3_f32 v142, v142, v133, v134
    v_max3_f32 v142, v142, v135, v140
    v_mov_b32 v143, v142
    s_nop 1
    v_permlane16_swap_b32 v142, v143
    v_max_f32 v142, v142, v143
    v_mov_b32 v143, v142
    s_nop 1
    v_permlane32_swap_b32 v142, v143
    v_max_f32 v142, v142, v143
    v_sub_f32 v144, v140, v142
    v_mul_f32 v144, s52, v144
    v_mov_b32 v140, v142
    v_exp_f32 v144, v144
    v_mul_f32 v145, s52, v142
    v_fma_f32 v128, v128, s52, -v145
    v_fma_f32 v129, v129, s52, -v145
    v_fma_f32 v130, v130, s52, -v145
    v_fma_f32 v131, v131, s52, -v145
    v_fma_f32 v132, v132, s52, -v145
    v_fma_f32 v133, v133, s52, -v145
    v_fma_f32 v134, v134, s52, -v145
    v_fma_f32 v135, v135, s52, -v145
    v_exp_f32 v128, v128
    v_exp_f32 v129, v129
    v_exp_f32 v130, v130
    v_exp_f32 v131, v131
    v_exp_f32 v132, v132
    v_exp_f32 v133, v133
    v_exp_f32 v134, v134
    v_exp_f32 v135, v135
    v_mul_f32 v141, v141, v144
    v_mul_f32 v96, v96, v144
    v_mul_f32 v100, v100, v144
    v_mul_f32 v104, v104, v144
    v_mul_f32 v108, v108, v144
    v_mul_f32 v112, v112, v144
    v_mul_f32 v116, v116, v144
    v_mul_f32 v120, v120, v144
    v_mul_f32 v124, v124, v144
    v_cvt_pk_bf16_f32 v136, v128, v129
    v_cvt_pk_bf16_f32 v137, v130, v131
    v_cvt_pk_bf16_f32 v138, v132, v133
    v_cvt_pk_bf16_f32 v139, v134, v135
    v_add_f32 v142, v128, v129
    v_add_f32 v143, v130, v131
    v_add_f32 v142, v142, v132
    v_add_f32 v143, v143, v133
    v_add_f32 v142, v142, v134
    v_add_f32 v143, v143, v135
    v_add_f32 v142, v142, v143
    v_add_f32 v141, v141, v142
    s_waitcnt lgkmcnt(0)
    v_mfma_f32_16x16x32_bf16 v[96:99], v[136:139], v[64:67], v[96:99]
    v_mfma_f32_16x16x32_bf16 v[100:103], v[136:139], v[68:71], v[100:103]
    v_mfma_f32_16x16x32_bf16 v[104:107], v[136:139], v[72:75], v[104:107]
    v_mfma_f32_16x16x32_bf16 v[108:111], v[136:139], v[76:79], v[108:111]
    v_mfma_f32_16x16x32_bf16 v[112:115], v[136:139], v[80:83], v[112:115]
    v_mfma_f32_16x16x32_bf16 v[116:119], v[136:139], v[84:87], v[116:119]
    v_mfma_f32_16x16x32_bf16 v[120:123], v[136:139], v[88:91], v[120:123]
    v_mfma_f32_16x16x32_bf16 v[124:127], v[136:139], v[92:95], v[124:127]
    s_add_u32 m0, s51, 8192
    s_add_u32 s50, s49, 4096
    buffer_load_dwordx4 v2, s[44:47], s49 offen offset:0 nt lds
    buffer_load_dwordx4 v3, s[44:47], s49 offen offset:1024 nt lds
    buffer_load_dwordx4 v2, s[44:47], s49 offen offset:2048 nt lds
    buffer_load_dwordx4 v3, s[44:47], s49 offen offset:3072 nt lds
    s_add_u32 m0, s51, 12288
    s_add_u32 s49, s49, 32768
    buffer_load_dwordx4 v2, s[44:47], s50 offen offset:0 nt lds
    buffer_load_dwordx4 v3, s[44:47], s50 offen offset:1024 nt lds
    buffer_load_dwordx4 v2, s[44:47], s50 offen offset:2048 nt lds
    buffer_load_dwordx4 v3, s[44:47], s50 offen offset:3072 nt lds
    s_sub_u32 s53, s53, 1
    s_cmp_eq_u32 s53, 0
    s_cbranch_scc1 Ldone_6
    s_waitcnt vmcnt(24)
    ds_read_b128 v[32:35], v4 offset:16384
    ds_read_b128 v[36:39], v5 offset:16384
    ds_read_b128 v[40:43], v6 offset:16384
    ds_read_b128 v[44:47], v7 offset:16384
    ds_read_b128 v[48:51], v4 offset:20480
    ds_read_b128 v[52:55], v5 offset:20480
    ds_read_b128 v[56:59], v6 offset:20480
    ds_read_b128 v[60:63], v7 offset:20480
    s_waitcnt lgkmcnt(3)
    s_waitcnt lgkmcnt(0)
    v_mfma_f32_16x16x32_bf16 v[128:131], v[32:35], v[16:19], 0
    s_waitcnt lgkmcnt(0)
    v_mfma_f32_16x16x32_bf16 v[132:135], v[48:51], v[16:19], 0
    v_mfma_f32_16x16x32_bf16 v[128:131], v[36:39], v[20:23], v[128:131]
    v_mfma_f32_16x16x32_bf16 v[132:135], v[52:55], v[20:23], v[132:135]
    v_mfma_f32_16x16x32_bf16 v[128:131], v[40:43], v[24:27], v[128:131]
    v_mfma_f32_16x16x32_bf16 v[132:135], v[56:59], v[24:27], v[132:135]
    v_mfma_f32_16x16x32_bf16 v[128:131], v[44:47], v[28:31], v[128:131]
    v_mfma_f32_16x16x32_bf16 v[132:135], v[60:63], v[28:31], v[132:135]
    s_add_u32 m0, s51, 16384
    s_add_u32 s50, s48, 4096
    buffer_load_dwordx4 v2, s[40:43], s48 offen offset:0 nt lds
    buffer_load_dwordx4 v3, s[40:43], s48 offen offset:1024 nt lds
    buffer_load_dwordx4 v2, s[40:43], s48 offen offset:2048 nt lds
    buffer_load_dwordx4 v3, s[40:43], s48 offen offset:3072 nt lds
    s_add_u32 m0, s51, 20480
    s_add_u32 s48, s48, 32768
    buffer_load_dwordx4 v2, s[40:43], s50 offen offset:0 nt lds
    buffer_load_dwordx4 v3, s[40:43], s50 offen offset:1024 nt lds
    buffer_load_dwordx4 v2, s[40:43], s50 offen offset:2048 nt lds
    buffer_load_dwordx4 v3, s[40:43], s50 offen offset:3072 nt lds
    s_waitcnt vmcnt(24)
    ds_read_b64_tr_b16 v[64:65], v8 offset:24576
    ds_read_b64_tr_b16 v[66:67], v8 offset:28672
    ds_read_b64_tr_b16 v[68:69], v9 offset:24576
    ds_read_b64_tr_b16 v[70:71], v9 offset:28672
    ds_read_b64_tr_b16 v[72:73], v10 offset:24576
    ds_read_b64_tr_b16 v[74:75], v10 offset:28672
    ds_read_b64_tr_b16 v[76:77], v11 offset:24576
    ds_read_b64_tr_b16 v[78:79], v11 offset:28672
    ds_read_b64_tr_b16 v[80:81], v12 offset:24576
    ds_read_b64_tr_b16 v[82:83], v12 offset:28672
    ds_read_b64_tr_b16 v[84:85], v13 offset:24576
    ds_read_b64_tr_b16 v[86:87], v13 offset:28672
    ds_read_b64_tr_b16 v[88:89], v14 offset:24576
    ds_read_b64_tr_b16 v[90:91], v14 offset:28672
    ds_read_b64_tr_b16 v[92:93], v15 offset:24576
    ds_read_b64_tr_b16 v[94:95], v15 offset:28672
    v_max3_f32 v142, v128, v129, v130
    v_max3_f32 v142, v142, v131, v132
    v_max3_f32 v142, v142, v133, v134
    v_max3_f32 v142, v142, v135, v140
    v_mov_b32 v143, v142
    s_nop 1
    v_permlane16_swap_b32 v142, v143
    v_max_f32 v142, v142, v143
    v_mov_b32 v143, v142
    s_nop 1
    v_permlane32_swap_b32 v142, v143
    v_max_f32 v142, v142, v143
    v_sub_f32 v144, v140, v142
    v_mul_f32 v144, s52, v144
    v_mov_b32 v140, v142
    v_exp_f32 v144, v144
    v_mul_f32 v145, s52, v142
    v_fma_f32 v128, v128, s52, -v145
    v_fma_f32 v129, v129, s52, -v145
    v_fma_f32 v130, v130, s52, -v145
    v_fma_f32 v131, v131, s52, -v145
    v_fma_f32 v132, v132, s52, -v145
    v_fma_f32 v133, v133, s52, -v145
    v_fma_f32 v134, v134, s52, -v145
    v_fma_f32 v135, v135, s52, -v145
    v_exp_f32 v128, v128
    v_exp_f32 v129, v129
    v_exp_f32 v130, v130
    v_exp_f32 v131, v131
    v_exp_f32 v132, v132
    v_exp_f32 v133, v133
    v_exp_f32 v134, v134
    v_exp_f32 v135, v135
    v_mul_f32 v141, v141, v144
    v_mul_f32 v96, v96, v144
    v_mul_f32 v100, v100, v144
    v_mul_f32 v104, v104, v144
    v_mul_f32 v108, v108, v144
    v_mul_f32 v112, v112, v144
    v_mul_f32 v116, v116, v144
    v_mul_f32 v120, v120, v144
    v_mul_f32 v124, v124, v144
    v_cvt_pk_bf16_f32 v136, v128, v129
    v_cvt_pk_bf16_f32 v137, v130, v131
    v_cvt_pk_bf16_f32 v138, v132, v133
    v_cvt_pk_bf16_f32 v139, v134, v135
    v_add_f32 v142, v128, v129
    v_add_f32 v143, v130, v131
    v_add_f32 v142, v142, v132
    v_add_f32 v143, v143, v133
    v_add_f32 v142, v142, v134
    v_add_f32 v143, v143, v135
    v_add_f32 v142, v142, v143
    v_add_f32 v141, v141, v142
    s_waitcnt lgkmcnt(0)
    v_mfma_f32_16x16x32_bf16 v[96:99], v[136:139], v[64:67], v[96:99]
    v_mfma_f32_16x16x32_bf16 v[100:103], v[136:139], v[68:71], v[100:103]
    v_mfma_f32_16x16x32_bf16 v[104:107], v[136:139], v[72:75], v[104:107]
    v_mfma_f32_16x16x32_bf16 v[108:111], v[136:139], v[76:79], v[108:111]
    v_mfma_f32_16x16x32_bf16 v[112:115], v[136:139], v[80:83], v[112:115]
    v_mfma_f32_16x16x32_bf16 v[116:119], v[136:139], v[84:87], v[116:119]
    v_mfma_f32_16x16x32_bf16 v[120:123], v[136:139], v[88:91], v[120:123]
    v_mfma_f32_16x16x32_bf16 v[124:127], v[136:139], v[92:95], v[124:127]
    s_add_u32 m0, s51, 24576
    s_add_u32 s50, s49, 4096
    buffer_load_dwordx4 v2, s[44:47], s49 offen offset:0 nt lds
    buffer_load_dwordx4 v3, s[44:47], s49 offen offset:1024 nt lds
    buffer_load_dwordx4 v2, s[44:47], s49 offen offset:2048 nt lds
    buffer_load_dwordx4 v3, s[44:47], s49 offen offset:3072 nt lds
    s_add_u32 m0, s51, 28672
    s_add_u32 s49, s49, 32768
    buffer_load_dwordx4 v2, s[44:47], s50 offen offset:0 nt lds
    buffer_load_dwordx4 v3, s[44:47], s50 offen offset:1024 nt lds
    buffer_load_dwordx4 v2, s[44:47], s50 offen offset:2048 nt lds
    buffer_load_dwordx4 v3, s[44:47], s50 offen offset:3072 nt lds
    s_sub_u32 s53, s53, 1
    s_cmp_eq_u32 s53, 0
    s_cbranch_scc0 Lloop_5
Ldone_6:
    v_mov_b32 v148, 161920
    s_mov_b32 s33, 0x20000
Lflag:
    ds_read_b32 v149, v148 offset:4
    s_waitcnt lgkmcnt(0)
    v_readfirstlane_b32 s36, v149
    s_cmp_eq_u32 s36, 0
    s_cbranch_scc0 Lflagd
    s_sub_u32 s33, s33, 1
    s_cmp_eq_u32 s33, 0
    s_cbranch_scc0 Lflag
Lflagd:
    s_lshr_b32 s36, s2, 3
    s_lshl_b32 s36, s36, 8
    s_add_u32 s36, s36, 917504
    v_mov_b32 v148, s36
    v_mov_b32 v149, 1
    s_waitcnt vmcnt(24)
    ds_read_b128 v[32:35], v4 offset:0
    ds_read_b128 v[36:39], v5 offset:0
    ds_read_b128 v[40:43], v6 offset:0
    ds_read_b128 v[44:47], v7 offset:0
    ds_read_b128 v[48:51], v4 offset:4096
    ds_read_b128 v[52:55], v5 offset:4096
    ds_read_b128 v[56:59], v6 offset:4096
    ds_read_b128 v[60:63], v7 offset:4096
    s_waitcnt lgkmcnt(3)
    s_waitcnt lgkmcnt(0)
    v_mfma_f32_16x16x32_bf16 v[128:131], v[32:35], v[16:19], 0
    s_waitcnt lgkmcnt(0)
    v_mfma_f32_16x16x32_bf16 v[132:135], v[48:51], v[16:19], 0
    v_mfma_f32_16x16x32_bf16 v[128:131], v[36:39], v[20:23], v[128:131]
    v_mfma_f32_16x16x32_bf16 v[132:135], v[52:55], v[20:23], v[132:135]
    v_mfma_f32_16x16x32_bf16 v[128:131], v[40:43], v[24:27], v[128:131]
    v_mfma_f32_16x16x32_bf16 v[132:135], v[56:59], v[24:27], v[132:135]
    v_mfma_f32_16x16x32_bf16 v[128:131], v[44:47], v[28:31], v[128:131]
    v_mfma_f32_16x16x32_bf16 v[132:135], v[60:63], v[28:31], v[132:135]
    s_add_u32 m0, s51, 0
    s_add_u32 s50, s48, 4096
    buffer_load_dwordx4 v2, s[40:43], s48 offen offset:0 nt lds
    buffer_load_dwordx4 v3, s[40:43], s48 offen offset:1024 nt lds
    buffer_load_dwordx4 v2, s[40:43], s48 offen offset:2048 nt lds
    buffer_load_dwordx4 v3, s[40:43], s48 offen offset:3072 nt lds
    s_add_u32 m0, s51, 4096
    s_add_u32 s48, s48, 32768
    buffer_load_dwordx4 v2, s[40:43], s50 offen offset:0 nt lds
    buffer_load_dwordx4 v3, s[40:43], s50 offen offset:1024 nt lds
    buffer_load_dwordx4 v2, s[40:43], s50 offen offset:2048 nt lds
    buffer_load_dwordx4 v3, s[40:43], s50 offen offset:3072 nt lds
    v_mov_b32 v150, -1
    s_mov_b64 exec, 1
    global_atomic_add v150, v148, v149, s[30:31] sc0 sc1
    s_mov_b64 exec, -1
    s_waitcnt vmcnt(24)
    ds_read_b64_tr_b16 v[64:65], v8 offset:8192
    ds_read_b64_tr_b16 v[66:67], v8 offset:12288
    ds_read_b64_tr_b16 v[68:69], v9 offset:8192
    ds_read_b64_tr_b16 v[70:71], v9 offset:12288
    ds_read_b64_tr_b16 v[72:73], v10 offset:8192
    ds_read_b64_tr_b16 v[74:75], v10 offset:12288
    ds_read_b64_tr_b16 v[76:77], v11 offset:8192
    ds_read_b64_tr_b16 v[78:79], v11 offset:12288
    ds_read_b64_tr_b16 v[80:81], v12 offset:8192
    ds_read_b64_tr_b16 v[82:83], v12 offset:12288
    ds_read_b64_tr_b16 v[84:85], v13 offset:8192
    ds_read_b64_tr_b16 v[86:87], v13 offset:12288
    ds_read_b64_tr_b16 v[88:89], v14 offset:8192
    ds_read_b64_tr_b16 v[90:91], v14 offset:12288
    ds_read_b64_tr_b16 v[92:93], v15 offset:8192
    ds_read_b64_tr_b16 v[94:95], v15 offset:12288
    v_max3_f32 v142, v128, v129, v130
    v_max3_f32 v142, v142, v131, v132
    v_max3_f32 v142, v142, v133, v134
    v_max3_f32 v142, v142, v135, v140
    v_mov_b32 v143, v142
    s_nop 1
    v_permlane16_swap_b32 v142, v143
    v_max_f32 v142, v142, v143
    v_mov_b32 v143, v142
    s_nop 1
    v_permlane32_swap_b32 v142, v143
    v_max_f32 v142, v142, v143
    v_sub_f32 v144, v140, v142
    v_mul_f32 v144, s52, v144
    v_mov_b32 v140, v142
    v_exp_f32 v144, v144
    v_mul_f32 v145, s52, v142
    v_fma_f32 v128, v128, s52, -v145
    v_fma_f32 v129, v129, s52, -v145
    v_fma_f32 v130, v130, s52, -v145
    v_fma_f32 v131, v131, s52, -v145
    v_fma_f32 v132, v132, s52, -v145
    v_fma_f32 v133, v133, s52, -v145
    v_fma_f32 v134, v134, s52, -v145
    v_fma_f32 v135, v135, s52, -v145
    v_exp_f32 v128, v128
    v_exp_f32 v129, v129
    v_exp_f32 v130, v130
    v_exp_f32 v131, v131
    v_exp_f32 v132, v132
    v_exp_f32 v133, v133
    v_exp_f32 v134, v134
    v_exp_f32 v135, v135
    v_mul_f32 v141, v141, v144
    v_mul_f32 v96, v96, v144
    v_mul_f32 v100, v100, v144
    v_mul_f32 v104, v104, v144
    v_mul_f32 v108, v108, v144
    v_mul_f32 v112, v112, v144
    v_mul_f32 v116, v116, v144
    v_mul_f32 v120, v120, v144
    v_mul_f32 v124, v124, v144
    v_cvt_pk_bf16_f32 v136, v128, v129
    v_cvt_pk_bf16_f32 v137, v130, v131
    v_cvt_pk_bf16_f32 v138, v132, v133
    v_cvt_pk_bf16_f32 v139, v134, v135
    v_add_f32 v142, v128, v129
    v_add_f32 v143, v130, v131
    v_add_f32 v142, v142, v132
    v_add_f32 v143, v143, v133
    v_add_f32 v142, v142, v134
    v_add_f32 v143, v143, v135
    v_add_f32 v142, v142, v143
    v_add_f32 v141, v141, v142
    s_waitcnt lgkmcnt(0)
    v_mfma_f32_16x16x32_bf16 v[96:99], v[136:139], v[64:67], v[96:99]
    v_mfma_f32_16x16x32_bf16 v[100:103], v[136:139], v[68:71], v[100:103]
    v_mfma_f32_16x16x32_bf16 v[104:107], v[136:139], v[72:75], v[104:107]
    v_mfma_f32_16x16x32_bf16 v[108:111], v[136:139], v[76:79], v[108:111]
    v_mfma_f32_16x16x32_bf16 v[112:115], v[136:139], v[80:83], v[112:115]
    v_mfma_f32_16x16x32_bf16 v[116:119], v[136:139], v[84:87], v[116:119]
    v_mfma_f32_16x16x32_bf16 v[120:123], v[136:139], v[88:91], v[120:123]
    v_mfma_f32_16x16x32_bf16 v[124:127], v[136:139], v[92:95], v[124:127]
    s_add_u32 m0, s51, 8192
    s_add_u32 s50, s49, 4096
    buffer_load_dwordx4 v2, s[44:47], s49 offen offset:0 nt lds
    buffer_load_dwordx4 v3, s[44:47], s49 offen offset:1024 nt lds
    buffer_load_dwordx4 v2, s[44:47], s49 offen offset:2048 nt lds
    buffer_load_dwordx4 v3, s[44:47], s49 offen offset:3072 nt lds
    s_add_u32 m0, s51, 12288
    s_add_u32 s49, s49, 32768
    buffer_load_dwordx4 v2, s[44:47], s50 offen offset:0 nt lds
    buffer_load_dwordx4 v3, s[44:47], s50 offen offset:1024 nt lds
    buffer_load_dwordx4 v2, s[44:47], s50 offen offset:2048 nt lds
    buffer_load_dwordx4 v3, s[44:47], s50 offen offset:3072 nt lds
    s_waitcnt vmcnt(24)
    ds_read_b128 v[32:35], v4 offset:16384
    ds_read_b128 v[36:39], v5 offset:16384
    ds_read_b128 v[40:43], v6 offset:16384
    ds_read_b128 v[44:47], v7 offset:16384
    ds_read_b128 v[48:51], v4 offset:20480
    ds_read_b128 v[52:55], v5 offset:20480
    ds_read_b128 v[56:59], v6 offset:20480
    ds_read_b128 v[60:63], v7 offset:20480
    s_waitcnt lgkmcnt(3)
    s_waitcnt lgkmcnt(0)
    v_mfma_f32_16x16x32_bf16 v[128:131], v[32:35], v[16:19], 0
    s_waitcnt lgkmcnt(0)
    v_mfma_f32_16x16x32_bf16 v[132:135], v[48:51], v[16:19], 0
    v_mfma_f32_16x16x32_bf16 v[128:131], v[36:39], v[20:23], v[128:131]
    v_mfma_f32_16x16x32_bf16 v[132:135], v[52:55], v[20:23], v[132:135]
    v_mfma_f32_16x16x32_bf16 v[128:131], v[40:43], v[24:27], v[128:131]
    v_mfma_f32_16x16x32_bf16 v[132:135], v[56:59], v[24:27], v[132:135]
    v_mfma_f32_16x16x32_bf16 v[128:131], v[44:47], v[28:31], v[128:131]
    v_mfma_f32_16x16x32_bf16 v[132:135], v[60:63], v[28:31], v[132:135]
    s_add_u32 m0, s51, 16384
    s_add_u32 s50, s48, 4096
    buffer_load_dwordx4 v2, s[40:43], s48 offen offset:0 nt lds
    buffer_load_dwordx4 v3, s[40:43], s48 offen offset:1024 nt lds
    buffer_load_dwordx4 v2, s[40:43], s48 offen offset:2048 nt lds
    buffer_load_dwordx4 v3, s[40:43], s48 offen offset:3072 nt lds
    s_add_u32 m0, s51, 20480
    s_add_u32 s48, s48, 32768
    buffer_load_dwordx4 v2, s[40:43], s50 offen offset:0 nt lds
    buffer_load_dwordx4 v3, s[40:43], s50 offen offset:1024 nt lds
    buffer_load_dwordx4 v2, s[40:43], s50 offen offset:2048 nt lds
    buffer_load_dwordx4 v3, s[40:43], s50 offen offset:3072 nt lds
    v_mov_b32 v151, -1
    s_mov_b64 exec, 1
    global_atomic_add v151, v148, v149, s[30:31] sc0 sc1
    s_mov_b64 exec, -1
    s_waitcnt vmcnt(24)
    ds_read_b64_tr_b16 v[64:65], v8 offset:24576
    ds_read_b64_tr_b16 v[66:67], v8 offset:28672
    ds_read_b64_tr_b16 v[68:69], v9 offset:24576
    ds_read_b64_tr_b16 v[70:71], v9 offset:28672
    ds_read_b64_tr_b16 v[72:73], v10 offset:24576
    ds_read_b64_tr_b16 v[74:75], v10 offset:28672
    ds_read_b64_tr_b16 v[76:77], v11 offset:24576
    ds_read_b64_tr_b16 v[78:79], v11 offset:28672
    ds_read_b64_tr_b16 v[80:81], v12 offset:24576
    ds_read_b64_tr_b16 v[82:83], v12 offset:28672
    ds_read_b64_tr_b16 v[84:85], v13 offset:24576
    ds_read_b64_tr_b16 v[86:87], v13 offset:28672
    ds_read_b64_tr_b16 v[88:89], v14 offset:24576
    ds_read_b64_tr_b16 v[90:91], v14 offset:28672
    ds_read_b64_tr_b16 v[92:93], v15 offset:24576
    ds_read_b64_tr_b16 v[94:95], v15 offset:28672
    v_max3_f32 v142, v128, v129, v130
    v_max3_f32 v142, v142, v131, v132
    v_max3_f32 v142, v142, v133, v134
    v_max3_f32 v142, v142, v135, v140
    v_mov_b32 v143, v142
    s_nop 1
    v_permlane16_swap_b32 v142, v143
    v_max_f32 v142, v142, v143
    v_mov_b32 v143, v142
    s_nop 1
    v_permlane32_swap_b32 v142, v143
    v_max_f32 v142, v142, v143
    v_sub_f32 v144, v140, v142
    v_mul_f32 v144, s52, v144
    v_mov_b32 v140, v142
    v_exp_f32 v144, v144
    v_mul_f32 v145, s52, v142
    v_fma_f32 v128, v128, s52, -v145
    v_fma_f32 v129, v129, s52, -v145
    v_fma_f32 v130, v130, s52, -v145
    v_fma_f32 v131, v131, s52, -v145
    v_fma_f32 v132, v132, s52, -v145
    v_fma_f32 v133, v133, s52, -v145
    v_fma_f32 v134, v134, s52, -v145
    v_fma_f32 v135, v135, s52, -v145
    v_exp_f32 v128, v128
    v_exp_f32 v129, v129
    v_exp_f32 v130, v130
    v_exp_f32 v131, v131
    v_exp_f32 v132, v132
    v_exp_f32 v133, v133
    v_exp_f32 v134, v134
    v_exp_f32 v135, v135
    v_mul_f32 v141, v141, v144
    v_mul_f32 v96, v96, v144
    v_mul_f32 v100, v100, v144
    v_mul_f32 v104, v104, v144
    v_mul_f32 v108, v108, v144
    v_mul_f32 v112, v112, v144
    v_mul_f32 v116, v116, v144
    v_mul_f32 v120, v120, v144
    v_mul_f32 v124, v124, v144
    v_cvt_pk_bf16_f32 v136, v128, v129
    v_cvt_pk_bf16_f32 v137, v130, v131
    v_cvt_pk_bf16_f32 v138, v132, v133
    v_cvt_pk_bf16_f32 v139, v134, v135
    v_add_f32 v142, v128, v129
    v_add_f32 v143, v130, v131
    v_add_f32 v142, v142, v132
    v_add_f32 v143, v143, v133
    v_add_f32 v142, v142, v134
    v_add_f32 v143, v143, v135
    v_add_f32 v142, v142, v143
    v_add_f32 v141, v141, v142
    s_waitcnt lgkmcnt(0)
    v_mfma_f32_16x16x32_bf16 v[96:99], v[136:139], v[64:67], v[96:99]
    v_mfma_f32_16x16x32_bf16 v[100:103], v[136:139], v[68:71], v[100:103]
    v_mfma_f32_16x16x32_bf16 v[104:107], v[136:139], v[72:75], v[104:107]
    v_mfma_f32_16x16x32_bf16 v[108:111], v[136:139], v[76:79], v[108:111]
    v_mfma_f32_16x16x32_bf16 v[112:115], v[136:139], v[80:83], v[112:115]
    v_mfma_f32_16x16x32_bf16 v[116:119], v[136:139], v[84:87], v[116:119]
    v_mfma_f32_16x16x32_bf16 v[120:123], v[136:139], v[88:91], v[120:123]
    v_mfma_f32_16x16x32_bf16 v[124:127], v[136:139], v[92:95], v[124:127]
    s_add_u32 m0, s51, 24576
    s_add_u32 s50, s49, 4096
    buffer_load_dwordx4 v2, s[44:47], s49 offen offset:0 nt lds
    buffer_load_dwordx4 v3, s[44:47], s49 offen offset:1024 nt lds
    buffer_load_dwordx4 v2, s[44:47], s49 offen offset:2048 nt lds
    buffer_load_dwordx4 v3, s[44:47], s49 offen offset:3072 nt lds
    s_add_u32 m0, s51, 28672
    s_add_u32 s49, s49, 32768
    buffer_load_dwordx4 v2, s[44:47], s50 offen offset:0 nt lds
    buffer_load_dwordx4 v3, s[44:47], s50 offen offset:1024 nt lds
    buffer_load_dwordx4 v2, s[44:47], s50 offen offset:2048 nt lds
    buffer_load_dwordx4 v3, s[44:47], s50 offen offset:3072 nt lds
Ldyn:
    s_waitcnt vmcnt(24)
    v_readfirstlane_b32 s55, v150
    s_cmp_eq_u32 s55, -1
    s_cbranch_scc1 Lfb_7
Lfbk_8:
    s_cmp_ge_u32 s55, 192
    s_cbranch_scc1 Ldrain0
    s_lshl_b32 s48, s55, 13
    s_add_u32 s48, s48, 136839168
    s_mov_b32 s49, s48
    ds_read_b128 v[32:35], v4 offset:0
    ds_read_b128 v[36:39], v5 offset:0
    ds_read_b128 v[40:43], v6 offset:0
    ds_read_b128 v[44:47], v7 offset:0
    ds_read_b128 v[48:51], v4 offset:4096
    ds_read_b128 v[52:55], v5 offset:4096
    ds_read_b128 v[56:59], v6 offset:4096
    ds_read_b128 v[60:63], v7 offset:4096
    s_waitcnt lgkmcnt(3)
    s_waitcnt lgkmcnt(0)
    v_mfma_f32_16x16x32_bf16 v[128:131], v[32:35], v[16:19], 0
    s_waitcnt lgkmcnt(0)
    v_mfma_f32_16x16x32_bf16 v[132:135], v[48:51], v[16:19], 0
    v_mfma_f32_16x16x32_bf16 v[128:131], v[36:39], v[20:23], v[128:131]
    v_mfma_f32_16x16x32_bf16 v[132:135], v[52:55], v[20:23], v[132:135]
    v_mfma_f32_16x16x32_bf16 v[128:131], v[40:43], v[24:27], v[128:131]
    v_mfma_f32_16x16x32_bf16 v[132:135], v[56:59], v[24:27], v[132:135]
    v_mfma_f32_16x16x32_bf16 v[128:131], v[44:47], v[28:31], v[128:131]
    v_mfma_f32_16x16x32_bf16 v[132:135], v[60:63], v[28:31], v[132:135]
    s_add_u32 m0, s51, 0
    s_add_u32 s50, s48, 4096
    buffer_load_dwordx4 v2, s[40:43], s48 offen offset:0 nt lds
    buffer_load_dwordx4 v3, s[40:43], s48 offen offset:1024 nt lds
    buffer_load_dwordx4 v2, s[40:43], s48 offen offset:2048 nt lds
    buffer_load_dwordx4 v3, s[40:43], s48 offen offset:3072 nt lds
    s_add_u32 m0, s51, 4096
    s_add_u32 s48, s48, 32768
    buffer_load_dwordx4 v2, s[40:43], s50 offen offset:0 nt lds
    buffer_load_dwordx4 v3, s[40:43], s50 offen offset:1024 nt lds
    buffer_load_dwordx4 v2, s[40:43], s50 offen offset:2048 nt lds
    buffer_load_dwordx4 v3, s[40:43], s50 offen offset:3072 nt lds
    v_mov_b32 v150, -1
    s_mov_b64 exec, 1
    global_atomic_add v150, v148, v149, s[30:31] sc0 sc1
    s_mov_b64 exec, -1
    s_waitcnt vmcnt(24)
    ds_read_b64_tr_b16 v[64:65], v8 offset:8192
    ds_read_b64_tr_b16 v[66:67], v8 offset:12288
    ds_read_b64_tr_b16 v[68:69], v9 offset:8192
    ds_read_b64_tr_b16 v[70:71], v9 offset:12288
    ds_read_b64_tr_b16 v[72:73], v10 offset:8192
    ds_read_b64_tr_b16 v[74:75], v10 offset:12288
    ds_read_b64_tr_b16 v[76:77], v11 offset:8192
    ds_read_b64_tr_b16 v[78:79], v11 offset:12288
    ds_read_b64_tr_b16 v[80:81], v12 offset:8192
    ds_read_b64_tr_b16 v[82:83], v12 offset:12288
    ds_read_b64_tr_b16 v[84:85], v13 offset:8192
    ds_read_b64_tr_b16 v[86:87], v13 offset:12288
    ds_read_b64_tr_b16 v[88:89], v14 offset:8192
    ds_read_b64_tr_b16 v[90:91], v14 offset:12288
    ds_read_b64_tr_b16 v[92:93], v15 offset:8192
    ds_read_b64_tr_b16 v[94:95], v15 offset:12288
    v_max3_f32 v142, v128, v129, v130
    v_max3_f32 v142, v142, v131, v132
    v_max3_f32 v142, v142, v133, v134
    v_max3_f32 v142, v142, v135, v140
    v_mov_b32 v143, v142
    s_nop 1
    v_permlane16_swap_b32 v142, v143
    v_max_f32 v142, v142, v143
    v_mov_b32 v143, v142
    s_nop 1
    v_permlane32_swap_b32 v142, v143
    v_max_f32 v142, v142, v143
    v_sub_f32 v144, v140, v142
    v_mul_f32 v144, s52, v144
    v_mov_b32 v140, v142
    v_exp_f32 v144, v144
    v_mul_f32 v145, s52, v142
    v_fma_f32 v128, v128, s52, -v145
    v_fma_f32 v129, v129, s52, -v145
    v_fma_f32 v130, v130, s52, -v145
    v_fma_f32 v131, v131, s52, -v145
    v_fma_f32 v132, v132, s52, -v145
    v_fma_f32 v133, v133, s52, -v145
    v_fma_f32 v134, v134, s52, -v145
    v_fma_f32 v135, v135, s52, -v145
    v_exp_f32 v128, v128
    v_exp_f32 v129, v129
    v_exp_f32 v130, v130
    v_exp_f32 v131, v131
    v_exp_f32 v132, v132
    v_exp_f32 v133, v133
    v_exp_f32 v134, v134
    v_exp_f32 v135, v135
    v_mul_f32 v141, v141, v144
    v_mul_f32 v96, v96, v144
    v_mul_f32 v100, v100, v144
    v_mul_f32 v104, v104, v144
    v_mul_f32 v108, v108, v144
    v_mul_f32 v112, v112, v144
    v_mul_f32 v116, v116, v144
    v_mul_f32 v120, v120, v144
    v_mul_f32 v124, v124, v144
    v_cvt_pk_bf16_f32 v136, v128, v129
    v_cvt_pk_bf16_f32 v137, v130, v131
    v_cvt_pk_bf16_f32 v138, v132, v133
    v_cvt_pk_bf16_f32 v139, v134, v135
    v_add_f32 v142, v128, v129
    v_add_f32 v143, v130, v131
    v_add_f32 v142, v142, v132
    v_add_f32 v143, v143, v133
    v_add_f32 v142, v142, v134
    v_add_f32 v143, v143, v135
    v_add_f32 v142, v142, v143
    v_add_f32 v141, v141, v142
    s_waitcnt lgkmcnt(0)
    v_mfma_f32_16x16x32_bf16 v[96:99], v[136:139], v[64:67], v[96:99]
    v_mfma_f32_16x16x32_bf16 v[100:103], v[136:139], v[68:71], v[100:103]
    v_mfma_f32_16x16x32_bf16 v[104:107], v[136:139], v[72:75], v[104:107]
    v_mfma_f32_16x16x32_bf16 v[108:111], v[136:139], v[76:79], v[108:111]
    v_mfma_f32_16x16x32_bf16 v[112:115], v[136:139], v[80:83], v[112:115]
    v_mfma_f32_16x16x32_bf16 v[116:119], v[136:139], v[84:87], v[116:119]
    v_mfma_f32_16x16x32_bf16 v[120:123], v[136:139], v[88:91], v[120:123]
    v_mfma_f32_16x16x32_bf16 v[124:127], v[136:139], v[92:95], v[124:127]
    s_add_u32 m0, s51, 8192
    s_add_u32 s50, s49, 4096
    buffer_load_dwordx4 v2, s[44:47], s49 offen offset:0 nt lds
    buffer_load_dwordx4 v3, s[44:47], s49 offen offset:1024 nt lds
    buffer_load_dwordx4 v2, s[44:47], s49 offen offset:2048 nt lds
    buffer_load_dwordx4 v3, s[44:47], s49 offen offset:3072 nt lds
    s_add_u32 m0, s51, 12288
    s_add_u32 s49, s49, 32768
    buffer_load_dwordx4 v2, s[44:47], s50 offen offset:0 nt lds
    buffer_load_dwordx4 v3, s[44:47], s50 offen offset:1024 nt lds
    buffer_load_dwordx4 v2, s[44:47], s50 offen offset:2048 nt lds
    buffer_load_dwordx4 v3, s[44:47], s50 offen offset:3072 nt lds
    s_waitcnt vmcnt(24)
    v_readfirstlane_b32 s55, v151
    s_cmp_eq_u32 s55, -1
    s_cbranch_scc1 Lfb_9
Lfbk_10:
    s_cmp_ge_u32 s55, 192
    s_cbranch_scc1 Ldrain2
    s_lshl_b32 s48, s55, 13
    s_add_u32 s48, s48, 136839168
    s_mov_b32 s49, s48
    ds_read_b128 v[32:35], v4 offset:16384
    ds_read_b128 v[36:39], v5 offset:16384
    ds_read_b128 v[40:43], v6 offset:16384
    ds_read_b128 v[44:47], v7 offset:16384
    ds_read_b128 v[48:51], v4 offset:20480
    ds_read_b128 v[52:55], v5 offset:20480
    ds_read_b128 v[56:59], v6 offset:20480
    ds_read_b128 v[60:63], v7 offset:20480
    s_waitcnt lgkmcnt(3)
    s_waitcnt lgkmcnt(0)
    v_mfma_f32_16x16x32_bf16 v[128:131], v[32:35], v[16:19], 0
    s_waitcnt lgkmcnt(0)
    v_mfma_f32_16x16x32_bf16 v[132:135], v[48:51], v[16:19], 0
    v_mfma_f32_16x16x32_bf16 v[128:131], v[36:39], v[20:23], v[128:131]
    v_mfma_f32_16x16x32_bf16 v[132:135], v[52:55], v[20:23], v[132:135]
    v_mfma_f32_16x16x32_bf16 v[128:131], v[40:43], v[24:27], v[128:131]
    v_mfma_f32_16x16x32_bf16 v[132:135], v[56:59], v[24:27], v[132:135]
    v_mfma_f32_16x16x32_bf16 v[128:131], v[44:47], v[28:31], v[128:131]
    v_mfma_f32_16x16x32_bf16 v[132:135], v[60:63], v[28:31], v[132:135]
    s_add_u32 m0, s51, 16384
    s_add_u32 s50, s48, 4096
    buffer_load_dwordx4 v2, s[40:43], s48 offen offset:0 nt lds
    buffer_load_dwordx4 v3, s[40:43], s48 offen offset:1024 nt lds
    buffer_load_dwordx4 v2, s[40:43], s48 offen offset:2048 nt lds
    buffer_load_dwordx4 v3, s[40:43], s48 offen offset:3072 nt lds
    s_add_u32 m0, s51, 20480
    s_add_u32 s48, s48, 32768
    buffer_load_dwordx4 v2, s[40:43], s50 offen offset:0 nt lds
    buffer_load_dwordx4 v3, s[40:43], s50 offen offset:1024 nt lds
    buffer_load_dwordx4 v2, s[40:43], s50 offen offset:2048 nt lds
    buffer_load_dwordx4 v3, s[40:43], s50 offen offset:3072 nt lds
    v_mov_b32 v151, -1
    s_mov_b64 exec, 1
    global_atomic_add v151, v148, v149, s[30:31] sc0 sc1
    s_mov_b64 exec, -1
    s_waitcnt vmcnt(24)
    ds_read_b64_tr_b16 v[64:65], v8 offset:24576
    ds_read_b64_tr_b16 v[66:67], v8 offset:28672
    ds_read_b64_tr_b16 v[68:69], v9 offset:24576
    ds_read_b64_tr_b16 v[70:71], v9 offset:28672
    ds_read_b64_tr_b16 v[72:73], v10 offset:24576
    ds_read_b64_tr_b16 v[74:75], v10 offset:28672
    ds_read_b64_tr_b16 v[76:77], v11 offset:24576
    ds_read_b64_tr_b16 v[78:79], v11 offset:28672
    ds_read_b64_tr_b16 v[80:81], v12 offset:24576
    ds_read_b64_tr_b16 v[82:83], v12 offset:28672
    ds_read_b64_tr_b16 v[84:85], v13 offset:24576
    ds_read_b64_tr_b16 v[86:87], v13 offset:28672
    ds_read_b64_tr_b16 v[88:89], v14 offset:24576
    ds_read_b64_tr_b16 v[90:91], v14 offset:28672
    ds_read_b64_tr_b16 v[92:93], v15 offset:24576
    ds_read_b64_tr_b16 v[94:95], v15 offset:28672
    v_max3_f32 v142, v128, v129, v130
    v_max3_f32 v142, v142, v131, v132
    v_max3_f32 v142, v142, v133, v134
    v_max3_f32 v142, v142, v135, v140
    v_mov_b32 v143, v142
    s_nop 1
    v_permlane16_swap_b32 v142, v143
    v_max_f32 v142, v142, v143
    v_mov_b32 v143, v142
    s_nop 1
    v_permlane32_swap_b32 v142, v143
    v_max_f32 v142, v142, v143
    v_sub_f32 v144, v140, v142
    v_mul_f32 v144, s52, v144
    v_mov_b32 v140, v142
    v_exp_f32 v144, v144
    v_mul_f32 v145, s52, v142
    v_fma_f32 v128, v128, s52, -v145
    v_fma_f32 v129, v129, s52, -v145
    v_fma_f32 v130, v130, s52, -v145
    v_fma_f32 v131, v131, s52, -v145
    v_fma_f32 v132, v132, s52, -v145
    v_fma_f32 v133, v133, s52, -v145
    v_fma_f32 v134, v134, s52, -v145
    v_fma_f32 v135, v135, s52, -v145
    v_exp_f32 v128, v128
    v_exp_f32 v129, v129
    v_exp_f32 v130, v130
    v_exp_f32 v131, v131
    v_exp_f32 v132, v132
    v_exp_f32 v133, v133
    v_exp_f32 v134, v134
    v_exp_f32 v135, v135
    v_mul_f32 v141, v141, v144
    v_mul_f32 v96, v96, v144
    v_mul_f32 v100, v100, v144
    v_mul_f32 v104, v104, v144
    v_mul_f32 v108, v108, v144
    v_mul_f32 v112, v112, v144
    v_mul_f32 v116, v116, v144
    v_mul_f32 v120, v120, v144
    v_mul_f32 v124, v124, v144
    v_cvt_pk_bf16_f32 v136, v128, v129
    v_cvt_pk_bf16_f32 v137, v130, v131
    v_cvt_pk_bf16_f32 v138, v132, v133
    v_cvt_pk_bf16_f32 v139, v134, v135
    v_add_f32 v142, v128, v129
    v_add_f32 v143, v130, v131
    v_add_f32 v142, v142, v132
    v_add_f32 v143, v143, v133
    v_add_f32 v142, v142, v134
    v_add_f32 v143, v143, v135
    v_add_f32 v142, v142, v143
    v_add_f32 v141, v141, v142
    s_waitcnt lgkmcnt(0)
    v_mfma_f32_16x16x32_bf16 v[96:99], v[136:139], v[64:67], v[96:99]
    v_mfma_f32_16x16x32_bf16 v[100:103], v[136:139], v[68:71], v[100:103]
    v_mfma_f32_16x16x32_bf16 v[104:107], v[136:139], v[72:75], v[104:107]
    v_mfma_f32_16x16x32_bf16 v[108:111], v[136:139], v[76:79], v[108:111]
    v_mfma_f32_16x16x32_bf16 v[112:115], v[136:139], v[80:83], v[112:115]
    v_mfma_f32_16x16x32_bf16 v[116:119], v[136:139], v[84:87], v[116:119]
    v_mfma_f32_16x16x32_bf16 v[120:123], v[136:139], v[88:91], v[120:123]
    v_mfma_f32_16x16x32_bf16 v[124:127], v[136:139], v[92:95], v[124:127]
    s_add_u32 m0, s51, 24576
    s_add_u32 s50, s49, 4096
    buffer_load_dwordx4 v2, s[44:47], s49 offen offset:0 nt lds
    buffer_load_dwordx4 v3, s[44:47], s49 offen offset:1024 nt lds
    buffer_load_dwordx4 v2, s[44:47], s49 offen offset:2048 nt lds
    buffer_load_dwordx4 v3, s[44:47], s49 offen offset:3072 nt lds
    s_add_u32 m0, s51, 28672
    s_add_u32 s49, s49, 32768
    buffer_load_dwordx4 v2, s[44:47], s50 offen offset:0 nt lds
    buffer_load_dwordx4 v3, s[44:47], s50 offen offset:1024 nt lds
    buffer_load_dwordx4 v2, s[44:47], s50 offen offset:2048 nt lds
    buffer_load_dwordx4 v3, s[44:47], s50 offen offset:3072 nt lds
    s_branch Ldyn
Lfb_7:
    s_waitcnt vmcnt(0)
    v_readfirstlane_b32 s55, v150
    s_branch Lfbk_8
Lfb_9:
    s_waitcnt vmcnt(0)
    v_readfirstlane_b32 s55, v151
    s_branch Lfbk_10
Ldrain2:
    s_waitcnt vmcnt(24)
    ds_read_b128 v[32:35], v4 offset:16384
    ds_read_b128 v[36:39], v5 offset:16384
    ds_read_b128 v[40:43], v6 offset:16384
    ds_read_b128 v[44:47], v7 offset:16384
    ds_read_b128 v[48:51], v4 offset:20480
    ds_read_b128 v[52:55], v5 offset:20480
    ds_read_b128 v[56:59], v6 offset:20480
    ds_read_b128 v[60:63], v7 offset:20480
    s_waitcnt lgkmcnt(3)
    s_waitcnt lgkmcnt(0)
    v_mfma_f32_16x16x32_bf16 v[128:131], v[32:35], v[16:19], 0
    s_waitcnt lgkmcnt(0)
    v_mfma_f32_16x16x32_bf16 v[132:135], v[48:51], v[16:19], 0
    v_mfma_f32_16x16x32_bf16 v[128:131], v[36:39], v[20:23], v[128:131]
    v_mfma_f32_16x16x32_bf16 v[132:135], v[52:55], v[20:23], v[132:135]
    v_mfma_f32_16x16x32_bf16 v[128:131], v[40:43], v[24:27], v[128:131]
    v_mfma_f32_16x16x32_bf16 v[132:135], v[56:59], v[24:27], v[132:135]
    v_mfma_f32_16x16x32_bf16 v[128:131], v[44:47], v[28:31], v[128:131]
    v_mfma_f32_16x16x32_bf16 v[132:135], v[60:63], v[28:31], v[132:135]
    s_waitcnt vmcnt(16)
    ds_read_b64_tr_b16 v[64:65], v8 offset:24576
    ds_read_b64_tr_b16 v[66:67], v8 offset:28672
    ds_read_b64_tr_b16 v[68:69], v9 offset:24576
    ds_read_b64_tr_b16 v[70:71], v9 offset:28672
    ds_read_b64_tr_b16 v[72:73], v10 offset:24576
    ds_read_b64_tr_b16 v[74:75], v10 offset:28672
    ds_read_b64_tr_b16 v[76:77], v11 offset:24576
    ds_read_b64_tr_b16 v[78:79], v11 offset:28672
    ds_read_b64_tr_b16 v[80:81], v12 offset:24576
    ds_read_b64_tr_b16 v[82:83], v12 offset:28672
    ds_read_b64_tr_b16 v[84:85], v13 offset:24576
    ds_read_b64_tr_b16 v[86:87], v13 offset:28672
    ds_read_b64_tr_b16 v[88:89], v14 offset:24576
    ds_read_b64_tr_b16 v[90:91], v14 offset:28672
    ds_read_b64_tr_b16 v[92:93], v15 offset:24576
    ds_read_b64_tr_b16 v[94:95], v15 offset:28672
    v_max3_f32 v142, v128, v129, v130
    v_max3_f32 v142, v142, v131, v132
    v_max3_f32 v142, v142, v133, v134
    v_max3_f32 v142, v142, v135, v140
    v_mov_b32 v143, v142
    s_nop 1
    v_permlane16_swap_b32 v142, v143
    v_max_f32 v142, v142, v143
    v_mov_b32 v143, v142
    s_nop 1
    v_permlane32_swap_b32 v142, v143
    v_max_f32 v142, v142, v143
    v_sub_f32 v144, v140, v142
    v_mul_f32 v144, s52, v144
    v_mov_b32 v140, v142
    v_exp_f32 v144, v144
    v_mul_f32 v145, s52, v142
    v_fma_f32 v128, v128, s52, -v145
    v_fma_f32 v129, v129, s52, -v145
    v_fma_f32 v130, v130, s52, -v145
    v_fma_f32 v131, v131, s52, -v145
    v_fma_f32 v132, v132, s52, -v145
    v_fma_f32 v133, v133, s52, -v145
    v_fma_f32 v134, v134, s52, -v145
    v_fma_f32 v135, v135, s52, -v145
    v_exp_f32 v128, v128
    v_exp_f32 v129, v129
    v_exp_f32 v130, v130
    v_exp_f32 v131, v131
    v_exp_f32 v132, v132
    v_exp_f32 v133, v133
    v_exp_f32 v134, v134
    v_exp_f32 v135, v135
    v_mul_f32 v141, v141, v144
    v_mul_f32 v96, v96, v144
    v_mul_f32 v100, v100, v144
    v_mul_f32 v104, v104, v144
    v_mul_f32 v108, v108, v144
    v_mul_f32 v112, v112, v144
    v_mul_f32 v116, v116, v144
    v_mul_f32 v120, v120, v144
    v_mul_f32 v124, v124, v144
    v_cvt_pk_bf16_f32 v136, v128, v129
    v_cvt_pk_bf16_f32 v137, v130, v131
    v_cvt_pk_bf16_f32 v138, v132, v133
    v_cvt_pk_bf16_f32 v139, v134, v135
    v_add_f32 v142, v128, v129
    v_add_f32 v143, v130, v131
    v_add_f32 v142, v142, v132
    v_add_f32 v143, v143, v133
    v_add_f32 v142, v142, v134
    v_add_f32 v143, v143, v135
    v_add_f32 v142, v142, v143
    v_add_f32 v141, v141, v142
    s_waitcnt lgkmcnt(0)
    v_mfma_f32_16x16x32_bf16 v[96:99], v[136:139], v[64:67], v[96:99]
    v_mfma_f32_16x16x32_bf16 v[100:103], v[136:139], v[68:71], v[100:103]
    v_mfma_f32_16x16x32_bf16 v[104:107], v[136:139], v[72:75], v[104:107]
    v_mfma_f32_16x16x32_bf16 v[108:111], v[136:139], v[76:79], v[108:111]
    v_mfma_f32_16x16x32_bf16 v[112:115], v[136:139], v[80:83], v[112:115]
    v_mfma_f32_16x16x32_bf16 v[116:119], v[136:139], v[84:87], v[116:119]
    v_mfma_f32_16x16x32_bf16 v[120:123], v[136:139], v[88:91], v[120:123]
    v_mfma_f32_16x16x32_bf16 v[124:127], v[136:139], v[92:95], v[124:127]
    s_waitcnt vmcnt(8)
    ds_read_b128 v[32:35], v4 offset:0
    ds_read_b128 v[36:39], v5 offset:0
    ds_read_b128 v[40:43], v6 offset:0
    ds_read_b128 v[44:47], v7 offset:0
    ds_read_b128 v[48:51], v4 offset:4096
    ds_read_b128 v[52:55], v5 offset:4096
    ds_read_b128 v[56:59], v6 offset:4096
    ds_read_b128 v[60:63], v7 offset:4096
    s_waitcnt lgkmcnt(3)
    s_waitcnt lgkmcnt(0)
    v_mfma_f32_16x16x32_bf16 v[128:131], v[32:35], v[16:19], 0
    s_waitcnt lgkmcnt(0)
    v_mfma_f32_16x16x32_bf16 v[132:135], v[48:51], v[16:19], 0
    v_mfma_f32_16x16x32_bf16 v[128:131], v[36:39], v[20:23], v[128:131]
    v_mfma_f32_16x16x32_bf16 v[132:135], v[52:55], v[20:23], v[132:135]
    v_mfma_f32_16x16x32_bf16 v[128:131], v[40:43], v[24:27], v[128:131]
    v_mfma_f32_16x16x32_bf16 v[132:135], v[56:59], v[24:27], v[132:135]
    v_mfma_f32_16x16x32_bf16 v[128:131], v[44:47], v[28:31], v[128:131]
    v_mfma_f32_16x16x32_bf16 v[132:135], v[60:63], v[28:31], v[132:135]
    s_waitcnt vmcnt(0)
    ds_read_b64_tr_b16 v[64:65], v8 offset:8192
    ds_read_b64_tr_b16 v[66:67], v8 offset:12288
    ds_read_b64_tr_b16 v[68:69], v9 offset:8192
    ds_read_b64_tr_b16 v[70:71], v9 offset:12288
    ds_read_b64_tr_b16 v[72:73], v10 offset:8192
    ds_read_b64_tr_b16 v[74:75], v10 offset:12288
    ds_read_b64_tr_b16 v[76:77], v11 offset:8192
    ds_read_b64_tr_b16 v[78:79], v11 offset:12288
    ds_read_b64_tr_b16 v[80:81], v12 offset:8192
    ds_read_b64_tr_b16 v[82:83], v12 offset:12288
    ds_read_b64_tr_b16 v[84:85], v13 offset:8192
    ds_read_b64_tr_b16 v[86:87], v13 offset:12288
    ds_read_b64_tr_b16 v[88:89], v14 offset:8192
    ds_read_b64_tr_b16 v[90:91], v14 offset:12288
    ds_read_b64_tr_b16 v[92:93], v15 offset:8192
    ds_read_b64_tr_b16 v[94:95], v15 offset:12288
    v_max3_f32 v142, v128, v129, v130
    v_max3_f32 v142, v142, v131, v132
    v_max3_f32 v142, v142, v133, v134
    v_max3_f32 v142, v142, v135, v140
    v_mov_b32 v143, v142
    s_nop 1
    v_permlane16_swap_b32 v142, v143
    v_max_f32 v142, v142, v143
    v_mov_b32 v143, v142
    s_nop 1
    v_permlane32_swap_b32 v142, v143
    v_max_f32 v142, v142, v143
    v_sub_f32 v144, v140, v142
    v_mul_f32 v144, s52, v144
    v_mov_b32 v140, v142
    v_exp_f32 v144, v144
    v_mul_f32 v145, s52, v142
    v_fma_f32 v128, v128, s52, -v145
    v_fma_f32 v129, v129, s52, -v145
    v_fma_f32 v130, v130, s52, -v145
    v_fma_f32 v131, v131, s52, -v145
    v_fma_f32 v132, v132, s52, -v145
    v_fma_f32 v133, v133, s52, -v145
    v_fma_f32 v134, v134, s52, -v145
    v_fma_f32 v135, v135, s52, -v145
    v_exp_f32 v128, v128
    v_exp_f32 v129, v129
    v_exp_f32 v130, v130
    v_exp_f32 v131, v131
    v_exp_f32 v132, v132
    v_exp_f32 v133, v133
    v_exp_f32 v134, v134
    v_exp_f32 v135, v135
    v_mul_f32 v141, v141, v144
    v_mul_f32 v96, v96, v144
    v_mul_f32 v100, v100, v144
    v_mul_f32 v104, v104, v144
    v_mul_f32 v108, v108, v144
    v_mul_f32 v112, v112, v144
    v_mul_f32 v116, v116, v144
    v_mul_f32 v120, v120, v144
    v_mul_f32 v124, v124, v144
    v_cvt_pk_bf16_f32 v136, v128, v129
    v_cvt_pk_bf16_f32 v137, v130, v131
    v_cvt_pk_bf16_f32 v138, v132, v133
    v_cvt_pk_bf16_f32 v139, v134, v135
    v_add_f32 v142, v128, v129
    v_add_f32 v143, v130, v131
    v_add_f32 v142, v142, v132
    v_add_f32 v143, v143, v133
    v_add_f32 v142, v142, v134
    v_add_f32 v143, v143, v135
    v_add_f32 v142, v142, v143
    v_add_f32 v141, v141, v142
    s_waitcnt lgkmcnt(0)
    v_mfma_f32_16x16x32_bf16 v[96:99], v[136:139], v[64:67], v[96:99]
    v_mfma_f32_16x16x32_bf16 v[100:103], v[136:139], v[68:71], v[100:103]
    v_mfma_f32_16x16x32_bf16 v[104:107], v[136:139], v[72:75], v[104:107]
    v_mfma_f32_16x16x32_bf16 v[108:111], v[136:139], v[76:79], v[108:111]
    v_mfma_f32_16x16x32_bf16 v[112:115], v[136:139], v[80:83], v[112:115]
    v_mfma_f32_16x16x32_bf16 v[116:119], v[136:139], v[84:87], v[116:119]
    v_mfma_f32_16x16x32_bf16 v[120:123], v[136:139], v[88:91], v[120:123]
    v_mfma_f32_16x16x32_bf16 v[124:127], v[136:139], v[92:95], v[124:127]
    s_branch Ldrained
Ldrain0:
    s_waitcnt vmcnt(24)
    ds_read_b128 v[32:35], v4 offset:0
    ds_read_b128 v[36:39], v5 offset:0
    ds_read_b128 v[40:43], v6 offset:0
    ds_read_b128 v[44:47], v7 offset:0
    ds_read_b128 v[48:51], v4 offset:4096
    ds_read_b128 v[52:55], v5 offset:4096
    ds_read_b128 v[56:59], v6 offset:4096
    ds_read_b128 v[60:63], v7 offset:4096
    s_waitcnt lgkmcnt(3)
    s_waitcnt lgkmcnt(0)
    v_mfma_f32_16x16x32_bf16 v[128:131], v[32:35], v[16:19], 0
    s_waitcnt lgkmcnt(0)
    v_mfma_f32_16x16x32_bf16 v[132:135], v[48:51], v[16:19], 0
    v_mfma_f32_16x16x32_bf16 v[128:131], v[36:39], v[20:23], v[128:131]
    v_mfma_f32_16x16x32_bf16 v[132:135], v[52:55], v[20:23], v[132:135]
    v_mfma_f32_16x16x32_bf16 v[128:131], v[40:43], v[24:27], v[128:131]
    v_mfma_f32_16x16x32_bf16 v[132:135], v[56:59], v[24:27], v[132:135]
    v_mfma_f32_16x16x32_bf16 v[128:131], v[44:47], v[28:31], v[128:131]
    v_mfma_f32_16x16x32_bf16 v[132:135], v[60:63], v[28:31], v[132:135]
    s_waitcnt vmcnt(16)
    ds_read_b64_tr_b16 v[64:65], v8 offset:8192
    ds_read_b64_tr_b16 v[66:67], v8 offset:12288
    ds_read_b64_tr_b16 v[68:69], v9 offset:8192
    ds_read_b64_tr_b16 v[70:71], v9 offset:12288
    ds_read_b64_tr_b16 v[72:73], v10 offset:8192
    ds_read_b64_tr_b16 v[74:75], v10 offset:12288
    ds_read_b64_tr_b16 v[76:77], v11 offset:8192
    ds_read_b64_tr_b16 v[78:79], v11 offset:12288
    ds_read_b64_tr_b16 v[80:81], v12 offset:8192
    ds_read_b64_tr_b16 v[82:83], v12 offset:12288
    ds_read_b64_tr_b16 v[84:85], v13 offset:8192
    ds_read_b64_tr_b16 v[86:87], v13 offset:12288
    ds_read_b64_tr_b16 v[88:89], v14 offset:8192
    ds_read_b64_tr_b16 v[90:91], v14 offset:12288
    ds_read_b64_tr_b16 v[92:93], v15 offset:8192
    ds_read_b64_tr_b16 v[94:95], v15 offset:12288
    v_max3_f32 v142, v128, v129, v130
    v_max3_f32 v142, v142, v131, v132
    v_max3_f32 v142, v142, v133, v134
    v_max3_f32 v142, v142, v135, v140
    v_mov_b32 v143, v142
    s_nop 1
    v_permlane16_swap_b32 v142, v143
    v_max_f32 v142, v142, v143
    v_mov_b32 v143, v142
    s_nop 1
    v_permlane32_swap_b32 v142, v143
    v_max_f32 v142, v142, v143
    v_sub_f32 v144, v140, v142
    v_mul_f32 v144, s52, v144
    v_mov_b32 v140, v142
    v_exp_f32 v144, v144
    v_mul_f32 v145, s52, v142
    v_fma_f32 v128, v128, s52, -v145
    v_fma_f32 v129, v129, s52, -v145
    v_fma_f32 v130, v130, s52, -v145
    v_fma_f32 v131, v131, s52, -v145
    v_fma_f32 v132, v132, s52, -v145
    v_fma_f32 v133, v133, s52, -v145
    v_fma_f32 v134, v134, s52, -v145
    v_fma_f32 v135, v135, s52, -v145
    v_exp_f32 v128, v128
    v_exp_f32 v129, v129
    v_exp_f32 v130, v130
    v_exp_f32 v131, v131
    v_exp_f32 v132, v132
    v_exp_f32 v133, v133
    v_exp_f32 v134, v134
    v_exp_f32 v135, v135
    v_mul_f32 v141, v141, v144
    v_mul_f32 v96, v96, v144
    v_mul_f32 v100, v100, v144
    v_mul_f32 v104, v104, v144
    v_mul_f32 v108, v108, v144
    v_mul_f32 v112, v112, v144
    v_mul_f32 v116, v116, v144
    v_mul_f32 v120, v120, v144
    v_mul_f32 v124, v124, v144
    v_cvt_pk_bf16_f32 v136, v128, v129
    v_cvt_pk_bf16_f32 v137, v130, v131
    v_cvt_pk_bf16_f32 v138, v132, v133
    v_cvt_pk_bf16_f32 v139, v134, v135
    v_add_f32 v142, v128, v129
    v_add_f32 v143, v130, v131
    v_add_f32 v142, v142, v132
    v_add_f32 v143, v143, v133
    v_add_f32 v142, v142, v134
    v_add_f32 v143, v143, v135
    v_add_f32 v142, v142, v143
    v_add_f32 v141, v141, v142
    s_waitcnt lgkmcnt(0)
    v_mfma_f32_16x16x32_bf16 v[96:99], v[136:139], v[64:67], v[96:99]
    v_mfma_f32_16x16x32_bf16 v[100:103], v[136:139], v[68:71], v[100:103]
    v_mfma_f32_16x16x32_bf16 v[104:107], v[136:139], v[72:75], v[104:107]
    v_mfma_f32_16x16x32_bf16 v[108:111], v[136:139], v[76:79], v[108:111]
    v_mfma_f32_16x16x32_bf16 v[112:115], v[136:139], v[80:83], v[112:115]
    v_mfma_f32_16x16x32_bf16 v[116:119], v[136:139], v[84:87], v[116:119]
    v_mfma_f32_16x16x32_bf16 v[120:123], v[136:139], v[88:91], v[120:123]
    v_mfma_f32_16x16x32_bf16 v[124:127], v[136:139], v[92:95], v[124:127]
    s_waitcnt vmcnt(8)
    ds_read_b128 v[32:35], v4 offset:16384
    ds_read_b128 v[36:39], v5 offset:16384
    ds_read_b128 v[40:43], v6 offset:16384
    ds_read_b128 v[44:47], v7 offset:16384
    ds_read_b128 v[48:51], v4 offset:20480
    ds_read_b128 v[52:55], v5 offset:20480
    ds_read_b128 v[56:59], v6 offset:20480
    ds_read_b128 v[60:63], v7 offset:20480
    s_waitcnt lgkmcnt(3)
    s_waitcnt lgkmcnt(0)
    v_mfma_f32_16x16x32_bf16 v[128:131], v[32:35], v[16:19], 0
    s_waitcnt lgkmcnt(0)
    v_mfma_f32_16x16x32_bf16 v[132:135], v[48:51], v[16:19], 0
    v_mfma_f32_16x16x32_bf16 v[128:131], v[36:39], v[20:23], v[128:131]
    v_mfma_f32_16x16x32_bf16 v[132:135], v[52:55], v[20:23], v[132:135]
    v_mfma_f32_16x16x32_bf16 v[128:131], v[40:43], v[24:27], v[128:131]
    v_mfma_f32_16x16x32_bf16 v[132:135], v[56:59], v[24:27], v[132:135]
    v_mfma_f32_16x16x32_bf16 v[128:131], v[44:47], v[28:31], v[128:131]
    v_mfma_f32_16x16x32_bf16 v[132:135], v[60:63], v[28:31], v[132:135]
    s_waitcnt vmcnt(0)
    ds_read_b64_tr_b16 v[64:65], v8 offset:24576
    ds_read_b64_tr_b16 v[66:67], v8 offset:28672
    ds_read_b64_tr_b16 v[68:69], v9 offset:24576
    ds_read_b64_tr_b16 v[70:71], v9 offset:28672
    ds_read_b64_tr_b16 v[72:73], v10 offset:24576
    ds_read_b64_tr_b16 v[74:75], v10 offset:28672
    ds_read_b64_tr_b16 v[76:77], v11 offset:24576
    ds_read_b64_tr_b16 v[78:79], v11 offset:28672
    ds_read_b64_tr_b16 v[80:81], v12 offset:24576
    ds_read_b64_tr_b16 v[82:83], v12 offset:28672
    ds_read_b64_tr_b16 v[84:85], v13 offset:24576
    ds_read_b64_tr_b16 v[86:87], v13 offset:28672
    ds_read_b64_tr_b16 v[88:89], v14 offset:24576
    ds_read_b64_tr_b16 v[90:91], v14 offset:28672
    ds_read_b64_tr_b16 v[92:93], v15 offset:24576
    ds_read_b64_tr_b16 v[94:95], v15 offset:28672
    v_max3_f32 v142, v128, v129, v130
    v_max3_f32 v142, v142, v131, v132
    v_max3_f32 v142, v142, v133, v134
    v_max3_f32 v142, v142, v135, v140
    v_mov_b32 v143, v142
    s_nop 1
    v_permlane16_swap_b32 v142, v143
    v_max_f32 v142, v142, v143
    v_mov_b32 v143, v142
    s_nop 1
    v_permlane32_swap_b32 v142, v143
    v_max_f32 v142, v142, v143
    v_sub_f32 v144, v140, v142
    v_mul_f32 v144, s52, v144
    v_mov_b32 v140, v142
    v_exp_f32 v144, v144
    v_mul_f32 v145, s52, v142
    v_fma_f32 v128, v128, s52, -v145
    v_fma_f32 v129, v129, s52, -v145
    v_fma_f32 v130, v130, s52, -v145
    v_fma_f32 v131, v131, s52, -v145
    v_fma_f32 v132, v132, s52, -v145
    v_fma_f32 v133, v133, s52, -v145
    v_fma_f32 v134, v134, s52, -v145
    v_fma_f32 v135, v135, s52, -v145
    v_exp_f32 v128, v128
    v_exp_f32 v129, v129
    v_exp_f32 v130, v130
    v_exp_f32 v131, v131
    v_exp_f32 v132, v132
    v_exp_f32 v133, v133
    v_exp_f32 v134, v134
    v_exp_f32 v135, v135
    v_mul_f32 v141, v141, v144
    v_mul_f32 v96, v96, v144
    v_mul_f32 v100, v100, v144
    v_mul_f32 v104, v104, v144
    v_mul_f32 v108, v108, v144
    v_mul_f32 v112, v112, v144
    v_mul_f32 v116, v116, v144
    v_mul_f32 v120, v120, v144
    v_mul_f32 v124, v124, v144
    v_cvt_pk_bf16_f32 v136, v128, v129
    v_cvt_pk_bf16_f32 v137, v130, v131
    v_cvt_pk_bf16_f32 v138, v132, v133
    v_cvt_pk_bf16_f32 v139, v134, v135
    v_add_f32 v142, v128, v129
    v_add_f32 v143, v130, v131
    v_add_f32 v142, v142, v132
    v_add_f32 v143, v143, v133
    v_add_f32 v142, v142, v134
    v_add_f32 v143, v143, v135
    v_add_f32 v142, v142, v143
    v_add_f32 v141, v141, v142
    s_waitcnt lgkmcnt(0)
    v_mfma_f32_16x16x32_bf16 v[96:99], v[136:139], v[64:67], v[96:99]
    v_mfma_f32_16x16x32_bf16 v[100:103], v[136:139], v[68:71], v[100:103]
    v_mfma_f32_16x16x32_bf16 v[104:107], v[136:139], v[72:75], v[104:107]
    v_mfma_f32_16x16x32_bf16 v[108:111], v[136:139], v[76:79], v[108:111]
    v_mfma_f32_16x16x32_bf16 v[112:115], v[136:139], v[80:83], v[112:115]
    v_mfma_f32_16x16x32_bf16 v[116:119], v[136:139], v[84:87], v[116:119]
    v_mfma_f32_16x16x32_bf16 v[120:123], v[136:139], v[88:91], v[120:123]
    v_mfma_f32_16x16x32_bf16 v[124:127], v[136:139], v[92:95], v[124:127]
Ldrained:
    s_nop 7
    s_nop 7
    v_mov_b32 v143, v141
    s_nop 1
    v_permlane16_swap_b32 v141, v143
    v_add_f32 v141, v141, v143
    v_mov_b32 v143, v141
    s_nop 1
    v_permlane32_swap_b32 v141, v143
    v_add_f32 v141, v141, v143
    s_mov_b64 exec, 0xffff
    ds_write_b32 v147, v96 offset:2112
    ds_write_b32 v147, v100 offset:2176
    ds_write_b32 v147, v104 offset:2240
    ds_write_b32 v147, v108 offset:2304
    ds_write_b32 v147, v112 offset:2368
    ds_write_b32 v147, v116 offset:2432
    ds_write_b32 v147, v120 offset:2496
    ds_write_b32 v147, v124 offset:2560
    s_mov_b64 exec, 1
    ds_write_b32 v147, v140 offset:2624
    ds_write_b32 v147, v141 offset:2628
    s_mov_b64 exec, -1
    s_waitcnt lgkmcnt(0)
    s_barrier
    s_cmp_eq_u32 s3, 0
    s_cbranch_scc0 Lst_noout
Lst_noout:
    s_cmp_lt_u32 s14, 80
    s_cbranch_scc1 Lend
    s_cmp_lt_u32 s14, 134
    s_cbranch_scc1 Lffn_x
    s_cmp_lt_u32 s14, 174
    s_cbranch_scc1 Lfin_d
    s_branch Lend
Lhelper:
    s_setprio 3
    s_sub_u32 s68, s3, 4
    v_and_b32 v2, 15, v1
    v_lshrrev_b32 v3, 4, v1
    v_and_b32 v4, 31, v1
    v_lshrrev_b32 v5, 5, v1
    s_and_b32 s66, s2, 31
    s_lshr_b32 s67, s2, 5
    v_mov_b32 v6, 161920
    v_mov_b32 v7, 0
    ds_write_b32 v6, v7
    ds_write_b32 v6, v7 offset:4
    s_waitcnt lgkmcnt(0)
    s_load_dword s32, s[30:31], 0
    s_and_b32 s14, s2, 7
    s_lshl_b32 s14, s14, 5
    s_lshr_b32 s36, s2, 3
    s_add_u32 s14, s14, s36
    s_mov_b32 s15, 0
    s_mov_b32 s60, s30
    s_and_b32 s61, s31, 0xffff
    s_mov_b32 s62, 11534336
    s_mov_b32 s63, 0x20000
    v_mov_b32 v10, v4
    v_add_u32 v11, 32, v4
    v_add_u32 v12, 64, v4
    v_min_u32 v12, 79, v12
    s_mul_i32 s69, s68, 640
    s_add_u32 s69, s69, 155776
    v_mul_u32_u24 v6, 320, v5
    v_add_u32 v6, s69, v6
    v_lshl_add_u32 v13, v10, 2, v6
    v_lshl_add_u32 v14, v11, 2, v6
    v_lshl_add_u32 v15, v12, 2, v6
    v_and_b32 v9, 1, v2
    v_mul_u32_u24 v9, 320, v9
    v_lshl_add_u32 v9, v3, 4, v9
    v_add_u32 v9, s69, v9
    v_lshlrev_b32 v8, 4, v5
    v_sub_u32 v8, 16, v8
    s_mul_i32 s70, s68, 160
    s_cmp_ge_u32 s67, 4
    s_cbranch_scc1 Lrole_m
    s_mov_b32 s56, s4
    s_and_b32 s57, s5, 0xffff
    s_mov_b32 s58, 2560
    s_mov_b32 s59, 0x20000
    v_mul_u32_u24 v6, 1280, v5
    v_lshl_add_u32 v7, v4, 2, v6
    buffer_load_dword v16, v7, s[56:59], 0 offen offset:0
    buffer_load_dword v17, v7, s[56:59], 0 offen offset:128
    buffer_load_dword v18, v7, s[56:59], 0 offen offset:256
    buffer_load_dword v19, v7, s[56:59], 0 offen offset:384
    buffer_load_dword v20, v7, s[56:59], 0 offen offset:512
    buffer_load_dword v21, v7, s[56:59], 0 offen offset:640
    buffer_load_dword v22, v7, s[56:59], 0 offen offset:768
    buffer_load_dword v23, v7, s[56:59], 0 offen offset:896
    buffer_load_dword v24, v7, s[56:59], 0 offen offset:1024
    buffer_load_dword v25, v7, s[56:59], 0 offen offset:1152
    s_lshl_b32 s71, s70, 1
    v_add_u32 v6, s71, v6
    v_lshl_add_u32 v7, v10, 2, v6
    buffer_load_dword v26, v7, s[56:59], 0 offen
    v_lshl_add_u32 v7, v11, 2, v6
    buffer_load_dword v27, v7, s[56:59], 0 offen
    v_lshl_add_u32 v7, v12, 2, v6
    buffer_load_dword v28, v7, s[56:59], 0 offen
    s_mov_b32 s56, s10
    s_and_b32 s57, s11, 0xffff
    s_mov_b32 s58, 5242880
    s_mov_b32 s59, 0x20000
    s_lshl_b32 s71, s66, 8
    s_lshl_b32 s72, s67, 6
    s_add_u32 s71, s71, s72
    s_lshl_b32 s72, s70, 13
    s_add_u32 s71, s71, s72
    v_lshlrev_b32 v7, 16, v3
    v_lshl_add_u32 v7, v2, 2, v7
    v_add_u32 v7, s71, v7
    buffer_load_dword v64, v7, s[56:59], 0 offen offset:0 nt
    s_mov_b32 s36, 8192
    buffer_load_dword v68, v7, s[56:59], s36 offen nt
    s_mov_b32 s36, 16384
    buffer_load_dword v65, v7, s[56:59], s36 offen nt
    s_mov_b32 s36, 24576
    buffer_load_dword v69, v7, s[56:59], s36 offen nt
    s_mov_b32 s36, 32768
    buffer_load_dword v66, v7, s[56:59], s36 offen nt
    s_mov_b32 s36, 40960
    buffer_load_dword v70, v7, s[56:59], s36 offen nt
    s_mov_b32 s36, 49152
    buffer_load_dword v67, v7, s[56:59], s36 offen nt
    s_mov_b32 s36, 57344
    buffer_load_dword v71, v7, s[56:59], s36 offen nt
    s_mov_b32 s36, 262144
    buffer_load_dword v72, v7, s[56:59], s36 offen nt
    s_mov_b32 s36, 270336
    buffer_load_dword v76, v7, s[56:59], s36 offen nt
    s_mov_b32 s36, 278528
    buffer_load_dword v73, v7, s[56:59], s36 offen nt
    s_mov_b32 s36, 286720
    buffer_load_dword v77, v7, s[56:59], s36 offen nt
    s_mov_b32 s36, 294912
    buffer_load_dword v74, v7, s[56:59], s36 offen nt
    s_mov_b32 s36, 303104
    buffer_load_dword v78, v7, s[56:59], s36 offen nt
    s_mov_b32 s36, 311296
    buffer_load_dword v75, v7, s[56:59], s36 offen nt
    s_mov_b32 s36, 319488
    buffer_load_dword v79, v7, s[56:59], s36 offen nt
    s_mov_b32 s36, 524288
    buffer_load_dword v80, v7, s[56:59], s36 offen nt
    s_mov_b32 s36, 532480
    buffer_load_dword v84, v7, s[56:59], s36 offen nt
    s_mov_b32 s36, 540672
    buffer_load_dword v81, v7, s[56:59], s36 offen nt
    s_mov_b32 s36, 548864
    buffer_load_dword v85, v7, s[56:59], s36 offen nt
    s_mov_b32 s36, 557056
    buffer_load_dword v82, v7, s[56:59], s36 offen nt
    s_mov_b32 s36, 565248
    buffer_load_dword v86, v7, s[56:59], s36 offen nt
    s_mov_b32 s36, 573440
    buffer_load_dword v83, v7, s[56:59], s36 offen nt
    s_mov_b32 s36, 581632
    buffer_load_dword v87, v7, s[56:59], s36 offen nt
    s_mov_b32 s36, 786432
    buffer_load_dword v88, v7, s[56:59], s36 offen nt
    s_mov_b32 s36, 794624
    buffer_load_dword v92, v7, s[56:59], s36 offen nt
    s_mov_b32 s36, 802816
    buffer_load_dword v89, v7, s[56:59], s36 offen nt
    s_mov_b32 s36, 811008
    buffer_load_dword v93, v7, s[56:59], s36 offen nt
    s_mov_b32 s36, 819200
    buffer_load_dword v90, v7, s[56:59], s36 offen nt
    s_mov_b32 s36, 827392
    buffer_load_dword v94, v7, s[56:59], s36 offen nt
    s_mov_b32 s36, 835584
    buffer_load_dword v91, v7, s[56:59], s36 offen nt
    s_mov_b32 s36, 843776
    buffer_load_dword v95, v7, s[56:59], s36 offen nt
    s_mov_b32 s36, 1048576
    buffer_load_dword v96, v7, s[56:59], s36 offen nt
    s_mov_b32 s36, 1056768
    buffer_load_dword v100, v7, s[56:59], s36 offen nt
    s_mov_b32 s36, 1064960
    buffer_load_dword v97, v7, s[56:59], s36 offen nt
    s_mov_b32 s36, 1073152
    buffer_load_dword v101, v7, s[56:59], s36 offen nt
    s_mov_b32 s36, 1081344
    buffer_load_dword v98, v7, s[56:59], s36 offen nt
    s_mov_b32 s36, 1089536
    buffer_load_dword v102, v7, s[56:59], s36 offen nt
    s_mov_b32 s36, 1097728
    buffer_load_dword v99, v7, s[56:59], s36 offen nt
    s_mov_b32 s36, 1105920
    buffer_load_dword v103, v7, s[56:59], s36 offen nt
    s_barrier
    s_waitcnt vmcnt(40)
    v_lshlrev_b32 v30, 16, v16
    v_and_b32 v31, 0xffff0000, v16
    v_lshlrev_b32 v32, 16, v17
    v_and_b32 v33, 0xffff0000, v17
    v_lshlrev_b32 v34, 16, v18
    v_and_b32 v35, 0xffff0000, v18
    v_lshlrev_b32 v36, 16, v19
    v_and_b32 v37, 0xffff0000, v19
    v_lshlrev_b32 v38, 16, v20
    v_and_b32 v39, 0xffff0000, v20
    v_lshlrev_b32 v40, 16, v21
    v_and_b32 v41, 0xffff0000, v21
    v_lshlrev_b32 v42, 16, v22
    v_and_b32 v43, 0xffff0000, v22
    v_lshlrev_b32 v44, 16, v23
    v_and_b32 v45, 0xffff0000, v23
    v_lshlrev_b32 v46, 16, v24
    v_and_b32 v47, 0xffff0000, v24
    v_lshlrev_b32 v48, 16, v25
    v_and_b32 v49, 0xffff0000, v25
    v_add_f32 v50, v30, v31
    v_add_f32 v50, v50, v32
    v_add_f32 v50, v50, v33
    v_add_f32 v50, v50, v34
    v_add_f32 v50, v50, v35
    v_add_f32 v50, v50, v36
    v_add_f32 v50, v50, v37
    v_add_f32 v50, v50, v38
    v_add_f32 v50, v50, v39
    v_add_f32 v50, v50, v40
    v_add_f32 v50, v50, v41
    v_add_f32 v50, v50, v42
    v_add_f32 v50, v50, v43
    v_add_f32 v50, v50, v44
    v_add_f32 v50, v50, v45
    v_add_f32 v50, v50, v46
    v_add_f32 v50, v50, v47
    v_add_f32 v50, v50, v48
    v_add_f32 v50, v50, v49
    s_nop 1
    v_add_f32_dpp v50, v50, v50 row_ror:8 row_mask:0xf bank_mask:0xf
    s_nop 1
    v_add_f32_dpp v50, v50, v50 row_ror:4 row_mask:0xf bank_mask:0xf
    s_nop 1
    v_add_f32_dpp v50, v50, v50 row_ror:2 row_mask:0xf bank_mask:0xf
    s_nop 1
    v_add_f32_dpp v50, v50, v50 row_ror:1 row_mask:0xf bank_mask:0xf
    v_mov_b32 v52, v50
    s_nop 1
    v_permlane16_swap_b32 v50, v52
    v_add_f32 v50, v50, v52
    v_mul_f32 v50, 0x3acccccd, v50
    v_sub_f32 v52, v30, v50
    v_mul_f32 v51, v52, v52
    v_sub_f32 v52, v31, v50
    v_fmac_f32 v51, v52, v52
    v_sub_f32 v52, v32, v50
    v_fmac_f32 v51, v52, v52
    v_sub_f32 v52, v33, v50
    v_fmac_f32 v51, v52, v52
    v_sub_f32 v52, v34, v50
    v_fmac_f32 v51, v52, v52
    v_sub_f32 v52, v35, v50
    v_fmac_f32 v51, v52, v52
    v_sub_f32 v52, v36, v50
    v_fmac_f32 v51, v52, v52
    v_sub_f32 v52, v37, v50
    v_fmac_f32 v51, v52, v52
    v_sub_f32 v52, v38, v50
    v_fmac_f32 v51, v52, v52
    v_sub_f32 v52, v39, v50
    v_fmac_f32 v51, v52, v52
    v_sub_f32 v52, v40, v50
    v_fmac_f32 v51, v52, v52
    v_sub_f32 v52, v41, v50
    v_fmac_f32 v51, v52, v52
    v_sub_f32 v52, v42, v50
    v_fmac_f32 v51, v52, v52
    v_sub_f32 v52, v43, v50
    v_fmac_f32 v51, v52, v52
    v_sub_f32 v52, v44, v50
    v_fmac_f32 v51, v52, v52
    v_sub_f32 v52, v45, v50
    v_fmac_f32 v51, v52, v52
    v_sub_f32 v52, v46, v50
    v_fmac_f32 v51, v52, v52
    v_sub_f32 v52, v47, v50
    v_fmac_f32 v51, v52, v52
    v_sub_f32 v52, v48, v50
    v_fmac_f32 v51, v52, v52
    v_sub_f32 v52, v49, v50
    v_fmac_f32 v51, v52, v52
    s_nop 1
    v_add_f32_dpp v51, v51, v51 row_ror:8 row_mask:0xf bank_mask:0xf
    s_nop 1
    v_add_f32_dpp v51, v51, v51 row_ror:4 row_mask:0xf bank_mask:0xf
    s_nop 1
    v_add_f32_dpp v51, v51, v51 row_ror:2 row_mask:0xf bank_mask:0xf
    s_nop 1
    v_add_f32_dpp v51, v51, v51 row_ror:1 row_mask:0xf bank_mask:0xf
    v_mov_b32 v52, v51
    s_nop 1
    v_permlane16_swap_b32 v51, v52
    v_add_f32 v51, v51, v52
    v_mul_f32 v51, 0x3acccccd, v51
    v_cvt_pk_bf16_f32 v51, v51, v51
    v_lshlrev_b32 v51, 16, v51
    v_add_f32 v51, 0x3727c5ac, v51
    v_cvt_pk_bf16_f32 v51, v51, v51
    v_lshlrev_b32 v51, 16, v51
    v_sqrt_f32 v51, v51
    s_nop 0
    v_cvt_pk_bf16_f32 v51, v51, v51
    v_lshlrev_b32 v51, 16, v51
    v_rcp_f32 v51, v51
    v_cvt_pk_bf16_f32 v50, v50, v50
    v_lshlrev_b32 v50, 16, v50
    v_lshlrev_b32 v30, 16, v26
    v_and_b32 v31, 0xffff0000, v26
    v_lshlrev_b32 v32, 16, v27
    v_and_b32 v33, 0xffff0000, v27
    v_lshlrev_b32 v34, 16, v28
    v_and_b32 v35, 0xffff0000, v28
    v_sub_f32 v30, v30, v50
    v_cvt_pk_bf16_f32 v30, v30, v30
    v_lshlrev_b32 v30, 16, v30
    v_mul_f32 v30, v30, v51
    v_cvt_pk_bf16_f32 v30, v30, v30
    v_lshlrev_b32 v30, 16, v30
    v_sub_f32 v31, v31, v50
    v_cvt_pk_bf16_f32 v31, v31, v31
    v_lshlrev_b32 v31, 16, v31
    v_mul_f32 v31, v31, v51
    v_cvt_pk_bf16_f32 v31, v31, v31
    v_lshlrev_b32 v31, 16, v31
    v_sub_f32 v32, v32, v50
    v_cvt_pk_bf16_f32 v32, v32, v32
    v_lshlrev_b32 v32, 16, v32
    v_mul_f32 v32, v32, v51
    v_cvt_pk_bf16_f32 v32, v32, v32
    v_lshlrev_b32 v32, 16, v32
    v_sub_f32 v33, v33, v50
    v_cvt_pk_bf16_f32 v33, v33, v33
    v_lshlrev_b32 v33, 16, v33
    v_mul_f32 v33, v33, v51
    v_cvt_pk_bf16_f32 v33, v33, v33
    v_lshlrev_b32 v33, 16, v33
    v_sub_f32 v34, v34, v50
    v_cvt_pk_bf16_f32 v34, v34, v34
    v_lshlrev_b32 v34, 16, v34
    v_mul_f32 v34, v34, v51
    v_cvt_pk_bf16_f32 v34, v34, v34
    v_lshlrev_b32 v34, 16, v34
    v_sub_f32 v35, v35, v50
    v_cvt_pk_bf16_f32 v35, v35, v35
    v_lshlrev_b32 v35, 16, v35
    v_mul_f32 v35, v35, v51
    v_cvt_pk_bf16_f32 v35, v35, v35
    v_lshlrev_b32 v35, 16, v35
    s_waitcnt vmcnt(0)
    v_perm_b32 v52, v68, v64, s64
    v_perm_b32 v68, v68, v64, s65
    v_mov_b32 v64, v52
    v_perm_b32 v52, v69, v65, s64
    v_perm_b32 v69, v69, v65, s65
    v_mov_b32 v65, v52
    v_perm_b32 v52, v70, v66, s64
    v_perm_b32 v70, v70, v66, s65
    v_mov_b32 v66, v52
    v_perm_b32 v52, v71, v67, s64
    v_perm_b32 v71, v71, v67, s65
    v_mov_b32 v67, v52
    v_perm_b32 v52, v76, v72, s64
    v_perm_b32 v76, v76, v72, s65
    v_mov_b32 v72, v52
    v_perm_b32 v52, v77, v73, s64
    v_perm_b32 v77, v77, v73, s65
    v_mov_b32 v73, v52
    v_perm_b32 v52, v78, v74, s64
    v_perm_b32 v78, v78, v74, s65
    v_mov_b32 v74, v52
    v_perm_b32 v52, v79, v75, s64
    v_perm_b32 v79, v79, v75, s65
    v_mov_b32 v75, v52
    v_perm_b32 v52, v84, v80, s64
    v_perm_b32 v84, v84, v80, s65
    v_mov_b32 v80, v52
    v_perm_b32 v52, v85, v81, s64
    v_perm_b32 v85, v85, v81, s65
    v_mov_b32 v81, v52
    v_perm_b32 v52, v86, v82, s64
    v_perm_b32 v86, v86, v82, s65
    v_mov_b32 v82, v52
    v_perm_b32 v52, v87, v83, s64
    v_perm_b32 v87, v87, v83, s65
    v_mov_b32 v83, v52
    v_perm_b32 v52, v92, v88, s64
    v_perm_b32 v92, v92, v88, s65
    v_mov_b32 v88, v52
    v_perm_b32 v52, v93, v89, s64
    v_perm_b32 v93, v93, v89, s65
    v_mov_b32 v89, v52
    v_perm_b32 v52, v94, v90, s64
    v_perm_b32 v94, v94, v90, s65
    v_mov_b32 v90, v52
    v_perm_b32 v52, v95, v91, s64
    v_perm_b32 v95, v95, v91, s65
    v_mov_b32 v91, v52
    v_perm_b32 v52, v100, v96, s64
    v_perm_b32 v100, v100, v96, s65
    v_mov_b32 v96, v52
    v_perm_b32 v52, v101, v97, s64
    v_perm_b32 v101, v101, v97, s65
    v_mov_b32 v97, v52
    v_perm_b32 v52, v102, v98, s64
    v_perm_b32 v102, v102, v98, s65
    v_mov_b32 v98, v52
    v_perm_b32 v52, v103, v99, s64
    v_perm_b32 v103, v103, v99, s65
    v_mov_b32 v99, v52
    s_waitcnt lgkmcnt(0)
    s_mul_i32 s32, s32, 1664525
    s_add_u32 s32, s32, 1013904223
    s_lshl_b32 s71, s70, 3
    s_add_u32 s71, s71, 65536
    v_lshl_add_u32 v53, v10, 4, s71
    v_lshl_add_u32 v54, v11, 4, s71
    v_lshl_add_u32 v55, v12, 4, s71
    s_mov_b64 s[34:35], exec
    s_mov_b32 s33, 0x8000
Lpoll_11:
    buffer_load_dwordx4 v[16:19], v53, s[60:63], 0 offen sc1
    s_movk_i32 s36, 5120
    buffer_load_dwordx4 v[36:39], v53, s[60:63], s36 offen sc1
    buffer_load_dwordx4 v[20:23], v54, s[60:63], 0 offen sc1
    s_movk_i32 s36, 5120
    buffer_load_dwordx4 v[40:43], v54, s[60:63], s36 offen sc1
    buffer_load_dwordx4 v[24:27], v55, s[60:63], 0 offen sc1
    s_movk_i32 s36, 5120
    buffer_load_dwordx4 v[44:47], v55, s[60:63], s36 offen sc1
    s_waitcnt vmcnt(0)
    v_cmp_ne_u32 s[38:39], s32, v17
    v_cmp_ne_u32 vcc, s32, v19
    s_or_b64 s[38:39], s[38:39], vcc
    v_cmp_ne_u32 vcc, s32, v21
    s_or_b64 s[38:39], s[38:39], vcc
    v_cmp_ne_u32 vcc, s32, v23
    s_or_b64 s[38:39], s[38:39], vcc
    v_cmp_ne_u32 vcc, s32, v25
    s_or_b64 s[38:39], s[38:39], vcc
    v_cmp_ne_u32 vcc, s32, v27
    s_or_b64 s[38:39], s[38:39], vcc
    v_cmp_ne_u32 vcc, s32, v37
    s_or_b64 s[38:39], s[38:39], vcc
    v_cmp_ne_u32 vcc, s32, v39
    s_or_b64 s[38:39], s[38:39], vcc
    v_cmp_ne_u32 vcc, s32, v41
    s_or_b64 s[38:39], s[38:39], vcc
    v_cmp_ne_u32 vcc, s32, v43
    s_or_b64 s[38:39], s[38:39], vcc
    v_cmp_ne_u32 vcc, s32, v45
    s_or_b64 s[38:39], s[38:39], vcc
    v_cmp_ne_u32 vcc, s32, v47
    s_or_b64 s[38:39], s[38:39], vcc
    s_and_b64 exec, exec, s[38:39]
    s_cbranch_execz Lpolld_12
    s_sub_u32 s33, s33, 1
    s_cmp_eq_u32 s33, 0
    s_cbranch_scc0 Lpoll_11
Lpolld_12:
    s_mov_b64 exec, s[34:35]
    v_lshlrev_b32 v56, v8, v36
    v_and_b32 v56, 0xffff0000, v56
    v_lshlrev_b32 v57, v8, v16
    v_and_b32 v57, 0xffff0000, v57
    v_add_f32 v56, 1.0, v56
    v_cvt_pk_bf16_f32 v56, v56, v56
    v_lshlrev_b32 v56, 16, v56
    v_mul_f32 v30, v30, v56
    v_cvt_pk_bf16_f32 v30, v30, v30
    v_lshlrev_b32 v30, 16, v30
    v_add_f32 v30, v30, v57
    v_lshlrev_b32 v56, v8, v38
    v_and_b32 v56, 0xffff0000, v56
    v_lshlrev_b32 v57, v8, v18
    v_and_b32 v57, 0xffff0000, v57
    v_add_f32 v56, 1.0, v56
    v_cvt_pk_bf16_f32 v56, v56, v56
    v_lshlrev_b32 v56, 16, v56
    v_mul_f32 v31, v31, v56
    v_cvt_pk_bf16_f32 v31, v31, v31
    v_lshlrev_b32 v31, 16, v31
    v_add_f32 v31, v31, v57
    v_lshlrev_b32 v56, v8, v40
    v_and_b32 v56, 0xffff0000, v56
    v_lshlrev_b32 v57, v8, v20
    v_and_b32 v57, 0xffff0000, v57
    v_add_f32 v56, 1.0, v56
    v_cvt_pk_bf16_f32 v56, v56, v56
    v_lshlrev_b32 v56, 16, v56
    v_mul_f32 v32, v32, v56
    v_cvt_pk_bf16_f32 v32, v32, v32
    v_lshlrev_b32 v32, 16, v32
    v_add_f32 v32, v32, v57
    v_lshlrev_b32 v56, v8, v42
    v_and_b32 v56, 0xffff0000, v56
    v_lshlrev_b32 v57, v8, v22
    v_and_b32 v57, 0xffff0000, v57
    v_add_f32 v56, 1.0, v56
    v_cvt_pk_bf16_f32 v56, v56, v56
    v_lshlrev_b32 v56, 16, v56
    v_mul_f32 v33, v33, v56
    v_cvt_pk_bf16_f32 v33, v33, v33
    v_lshlrev_b32 v33, 16, v33
    v_add_f32 v33, v33, v57
    v_lshlrev_b32 v56, v8, v44
    v_and_b32 v56, 0xffff0000, v56
    v_lshlrev_b32 v57, v8, v24
    v_and_b32 v57, 0xffff0000, v57
    v_add_f32 v56, 1.0, v56
    v_cvt_pk_bf16_f32 v56, v56, v56
    v_lshlrev_b32 v56, 16, v56
    v_mul_f32 v34, v34, v56
    v_cvt_pk_bf16_f32 v34, v34, v34
    v_lshlrev_b32 v34, 16, v34
    v_add_f32 v34, v34, v57
    v_lshlrev_b32 v56, v8, v46
    v_and_b32 v56, 0xffff0000, v56
    v_lshlrev_b32 v57, v8, v26
    v_and_b32 v57, 0xffff0000, v57
    v_add_f32 v56, 1.0, v56
    v_cvt_pk_bf16_f32 v56, v56, v56
    v_lshlrev_b32 v56, 16, v56
    v_mul_f32 v35, v35, v56
    v_cvt_pk_bf16_f32 v35, v35, v35
    v_lshlrev_b32 v35, 16, v35
    v_add_f32 v35, v35, v57
    v_cvt_pk_bf16_f32 v30, v30, v31
    ds_write_b32 v13, v30
    v_cvt_pk_bf16_f32 v31, v32, v33
    ds_write_b32 v14, v31
    v_cvt_pk_bf16_f32 v32, v34, v35
    ds_write_b32 v15, v32
    s_lshl_b32 s71, s66, 7
    s_lshl_b32 s72, s67, 5
    s_add_u32 s71, s71, s72
    s_lshl_b32 s71, s71, 3
    s_add_u32 s71, s71, 131072
    s_waitcnt lgkmcnt(0)
    ds_read_b128 v[16:19], v9 offset:0
    ds_read_b128 v[20:23], v9 offset:64
    ds_read_b128 v[24:27], v9 offset:128
    ds_read_b128 v[28:31], v9 offset:192
    ds_read_b128 v[32:35], v9 offset:256
    s_waitcnt lgkmcnt(0)
    v_mfma_f32_16x16x32_bf16 v[104:107], v[16:19], v[64:67], 0
    v_mfma_f32_16x16x32_bf16 v[108:111], v[16:19], v[68:71], 0
    v_mfma_f32_16x16x32_bf16 v[104:107], v[20:23], v[72:75], v[104:107]
    v_mfma_f32_16x16x32_bf16 v[108:111], v[20:23], v[76:79], v[108:111]
    v_mfma_f32_16x16x32_bf16 v[104:107], v[24:27], v[80:83], v[104:107]
    v_mfma_f32_16x16x32_bf16 v[108:111], v[24:27], v[84:87], v[108:111]
    v_mfma_f32_16x16x32_bf16 v[104:107], v[28:31], v[88:91], v[104:107]
    v_mfma_f32_16x16x32_bf16 v[108:111], v[28:31], v[92:95], v[108:111]
    v_mfma_f32_16x16x32_bf16 v[104:107], v[32:35], v[96:99], v[104:107]
    v_mfma_f32_16x16x32_bf16 v[108:111], v[32:35], v[100:103], v[108:111]
    s_lshl_b32 s72, s68, 8
    s_add_u32 s72, s72, 158336
    v_lshl_add_u32 v6, v2, 3, s72
    v_mov_b32 v7, 161920
    v_mov_b32 v20, 1
    s_nop 7
    s_mov_b64 exec, 0xffff
    ds_write2_b32 v6, v104, v108 offset0:0 offset1:1
    ds_write2_b32 v6, v105, v109 offset0:32 offset1:33
    s_waitcnt lgkmcnt(0)
    s_mov_b64 exec, 1
    ds_add_u32 v7, v20
    s_mov_b64 exec, -1
    s_add_u32 s15, s15, 4
    s_cmp_eq_u32 s68, 0
    s_cbranch_scc0 Lpubd_13
    s_mov_b32 s33, 0x40000
Lspin_14:
    ds_read_b32 v20, v7
    s_waitcnt lgkmcnt(0)
    v_readfirstlane_b32 s36, v20
    s_cmp_ge_u32 s36, s15
    s_cbranch_scc1 Lspind_15
    s_sub_u32 s33, s33, 1
    s_cmp_eq_u32 s33, 0
    s_cbranch_scc0 Lspin_14
Lspind_15:
    v_lshlrev_b32 v6, 2, v4
    v_add_u32 v6, 158336, v6
    ds_read_b32 v16, v6 offset:0
    ds_read_b32 v17, v6 offset:128
    ds_read_b32 v18, v6 offset:256
    ds_read_b32 v19, v6 offset:384
    ds_read_b32 v20, v6 offset:512
    ds_read_b32 v21, v6 offset:640
    ds_read_b32 v22, v6 offset:768
    ds_read_b32 v23, v6 offset:896
    s_waitcnt lgkmcnt(0)
    v_add_f32 v16, v16, v18
    v_add_f32 v17, v17, v19
    v_add_f32 v20, v20, v22
    v_add_f32 v21, v21, v23
    v_add_f32 v16, v16, v20
    v_add_f32 v17, v17, v21
    v_cvt_pk_bf16_f32 v16, v16, v17
    v_mov_b32 v17, s32
    v_lshl_add_u32 v6, v4, 3, s71
    s_mov_b32 exec_lo, -1
    s_mov_b32 exec_hi, 0
    buffer_store_dwordx2 v[16:17], v6, s[60:63], 0 offen sc1
    s_mov_b64 exec, -1
Lpubd_13:
    s_branch Lqpoll
Lrole_m:
    s_lshl_b32 s71, s66, 2
    s_add_u32 s71, s71, s67
    s_sub_u32 s73, s71, 4
    s_cmp_ge_u32 s73, 40
    s_cbranch_scc1 Lrole_none
    s_mov_b32 s56, s22
    s_and_b32 s57, s23, 0xffff
    s_mov_b32 s58, 2560
    s_mov_b32 s59, 0x20000
    v_mul_u32_u24 v6, 1280, v5
    s_lshl_b32 s71, s70, 1
    v_add_u32 v6, s71, v6
    v_lshl_add_u32 v7, v10, 2, v6
    buffer_load_dword v26, v7, s[56:59], 0 offen
    v_lshl_add_u32 v7, v11, 2, v6
    buffer_load_dword v27, v7, s[56:59], 0 offen
    v_lshl_add_u32 v7, v12, 2, v6
    buffer_load_dword v28, v7, s[56:59], 0 offen
    s_mov_b32 s56, s24
    s_and_b32 s57, s25, 0xffff
    s_mov_b32 s58, 4915200
    s_mov_b32 s59, 0x20000
    s_lshl_b32 s71, s73, 6
    s_mul_i32 s72, s70, 7680
    s_add_u32 s71, s71, s72
    v_mul_u32_u24 v7, 61440, v3
    v_lshl_add_u32 v7, v2, 2, v7
    v_add_u32 v7, s71, v7
    buffer_load_dword v64, v7, s[56:59], 0 offen offset:0 nt
    s_mov_b32 s36, 7680
    buffer_load_dword v68, v7, s[56:59], s36 offen nt
    s_mov_b32 s36, 15360
    buffer_load_dword v65, v7, s[56:59], s36 offen nt
    s_mov_b32 s36, 23040
    buffer_load_dword v69, v7, s[56:59], s36 offen nt
    s_mov_b32 s36, 30720
    buffer_load_dword v66, v7, s[56:59], s36 offen nt
    s_mov_b32 s36, 38400
    buffer_load_dword v70, v7, s[56:59], s36 offen nt
    s_mov_b32 s36, 46080
    buffer_load_dword v67, v7, s[56:59], s36 offen nt
    s_mov_b32 s36, 53760
    buffer_load_dword v71, v7, s[56:59], s36 offen nt
    s_mov_b32 s36, 245760
    buffer_load_dword v72, v7, s[56:59], s36 offen nt
    s_mov_b32 s36, 253440
    buffer_load_dword v76, v7, s[56:59], s36 offen nt
    s_mov_b32 s36, 261120
    buffer_load_dword v73, v7, s[56:59], s36 offen nt
    s_mov_b32 s36, 268800
    buffer_load_dword v77, v7, s[56:59], s36 offen nt
    s_mov_b32 s36, 276480
    buffer_load_dword v74, v7, s[56:59], s36 offen nt
    s_mov_b32 s36, 284160
    buffer_load_dword v78, v7, s[56:59], s36 offen nt
    s_mov_b32 s36, 291840
    buffer_load_dword v75, v7, s[56:59], s36 offen nt
    s_mov_b32 s36, 299520
    buffer_load_dword v79, v7, s[56:59], s36 offen nt
    s_mov_b32 s36, 491520
    buffer_load_dword v80, v7, s[56:59], s36 offen nt
    s_mov_b32 s36, 499200
    buffer_load_dword v84, v7, s[56:59], s36 offen nt
    s_mov_b32 s36, 506880
    buffer_load_dword v81, v7, s[56:59], s36 offen nt
    s_mov_b32 s36, 514560
    buffer_load_dword v85, v7, s[56:59], s36 offen nt
    s_mov_b32 s36, 522240
    buffer_load_dword v82, v7, s[56:59], s36 offen nt
    s_mov_b32 s36, 529920
    buffer_load_dword v86, v7, s[56:59], s36 offen nt
    s_mov_b32 s36, 537600
    buffer_load_dword v83, v7, s[56:59], s36 offen nt
    s_mov_b32 s36, 545280
    buffer_load_dword v87, v7, s[56:59], s36 offen nt
    s_mov_b32 s36, 737280
    buffer_load_dword v88, v7, s[56:59], s36 offen nt
    s_mov_b32 s36, 744960
    buffer_load_dword v92, v7, s[56:59], s36 offen nt
    s_mov_b32 s36, 752640
    buffer_load_dword v89, v7, s[56:59], s36 offen nt
    s_mov_b32 s36, 760320
    buffer_load_dword v93, v7, s[56:59], s36 offen nt
    s_mov_b32 s36, 768000
    buffer_load_dword v90, v7, s[56:59], s36 offen nt
    s_mov_b32 s36, 775680
    buffer_load_dword v94, v7, s[56:59], s36 offen nt
    s_mov_b32 s36, 783360
    buffer_load_dword v91, v7, s[56:59], s36 offen nt
    s_mov_b32 s36, 791040
    buffer_load_dword v95, v7, s[56:59], s36 offen nt
    s_mov_b32 s36, 983040
    buffer_load_dword v96, v7, s[56:59], s36 offen nt
    s_mov_b32 s36, 990720
    buffer_load_dword v100, v7, s[56:59], s36 offen nt
    s_mov_b32 s36, 998400
    buffer_load_dword v97, v7, s[56:59], s36 offen nt
    s_mov_b32 s36, 1006080
    buffer_load_dword v101, v7, s[56:59], s36 offen nt
    s_mov_b32 s36, 1013760
    buffer_load_dword v98, v7, s[56:59], s36 offen nt
    s_mov_b32 s36, 1021440
    buffer_load_dword v102, v7, s[56:59], s36 offen nt
    s_mov_b32 s36, 1029120
    buffer_load_dword v99, v7, s[56:59], s36 offen nt
    s_mov_b32 s36, 1036800
    buffer_load_dword v103, v7, s[56:59], s36 offen nt
    s_barrier
    s_waitcnt vmcnt(40)
    v_lshlrev_b32 v30, 16, v26
    v_and_b32 v31, 0xffff0000, v26
    v_lshlrev_b32 v32, 16, v27
    v_and_b32 v33, 0xffff0000, v27
    v_lshlrev_b32 v34, 16, v28
    v_and_b32 v35, 0xffff0000, v28
    v_mul_f32 v56, s37, v30
    v_exp_f32 v56, v56
    s_nop 0
    v_add_f32 v56, 1.0, v56
    v_rcp_f32 v56, v56
    s_nop 0
    v_mul_f32 v30, v30, v56
    v_mul_f32 v56, s37, v31
    v_exp_f32 v56, v56
    s_nop 0
    v_add_f32 v56, 1.0, v56
    v_rcp_f32 v56, v56
    s_nop 0
    v_mul_f32 v31, v31, v56
    v_mul_f32 v56, s37, v32
    v_exp_f32 v56, v56
    s_nop 0
    v_add_f32 v56, 1.0, v56
    v_rcp_f32 v56, v56
    s_nop 0
    v_mul_f32 v32, v32, v56
    v_mul_f32 v56, s37, v33
    v_exp_f32 v56, v56
    s_nop 0
    v_add_f32 v56, 1.0, v56
    v_rcp_f32 v56, v56
    s_nop 0
    v_mul_f32 v33, v33, v56
    v_mul_f32 v56, s37, v34
    v_exp_f32 v56, v56
    s_nop 0
    v_add_f32 v56, 1.0, v56
    v_rcp_f32 v56, v56
    s_nop 0
    v_mul_f32 v34, v34, v56
    v_mul_f32 v56, s37, v35
    v_exp_f32 v56, v56
    s_nop 0
    v_add_f32 v56, 1.0, v56
    v_rcp_f32 v56, v56
    s_nop 0
    v_mul_f32 v35, v35, v56
    v_cvt_pk_bf16_f32 v30, v30, v31
    ds_write_b32 v13, v30
    v_cvt_pk_bf16_f32 v31, v32, v33
    ds_write_b32 v14, v31
    v_cvt_pk_bf16_f32 v32, v34, v35
    ds_write_b32 v15, v32
    s_waitcnt vmcnt(0)
    v_perm_b32 v52, v68, v64, s64
    v_perm_b32 v68, v68, v64, s65
    v_mov_b32 v64, v52
    v_perm_b32 v52, v69, v65, s64
    v_perm_b32 v69, v69, v65, s65
    v_mov_b32 v65, v52
    v_perm_b32 v52, v70, v66, s64
    v_perm_b32 v70, v70, v66, s65
    v_mov_b32 v66, v52
    v_perm_b32 v52, v71, v67, s64
    v_perm_b32 v71, v71, v67, s65
    v_mov_b32 v67, v52
    v_perm_b32 v52, v76, v72, s64
    v_perm_b32 v76, v76, v72, s65
    v_mov_b32 v72, v52
    v_perm_b32 v52, v77, v73, s64
    v_perm_b32 v77, v77, v73, s65
    v_mov_b32 v73, v52
    v_perm_b32 v52, v78, v74, s64
    v_perm_b32 v78, v78, v74, s65
    v_mov_b32 v74, v52
    v_perm_b32 v52, v79, v75, s64
    v_perm_b32 v79, v79, v75, s65
    v_mov_b32 v75, v52
    v_perm_b32 v52, v84, v80, s64
    v_perm_b32 v84, v84, v80, s65
    v_mov_b32 v80, v52
    v_perm_b32 v52, v85, v81, s64
    v_perm_b32 v85, v85, v81, s65
    v_mov_b32 v81, v52
    v_perm_b32 v52, v86, v82, s64
    v_perm_b32 v86, v86, v82, s65
    v_mov_b32 v82, v52
    v_perm_b32 v52, v87, v83, s64
    v_perm_b32 v87, v87, v83, s65
    v_mov_b32 v83, v52
    v_perm_b32 v52, v92, v88, s64
    v_perm_b32 v92, v92, v88, s65
    v_mov_b32 v88, v52
    v_perm_b32 v52, v93, v89, s64
    v_perm_b32 v93, v93, v89, s65
    v_mov_b32 v89, v52
    v_perm_b32 v52, v94, v90, s64
    v_perm_b32 v94, v94, v90, s65
    v_mov_b32 v90, v52
    v_perm_b32 v52, v95, v91, s64
    v_perm_b32 v95, v95, v91, s65
    v_mov_b32 v91, v52
    v_perm_b32 v52, v100, v96, s64
    v_perm_b32 v100, v100, v96, s65
    v_mov_b32 v96, v52
    v_perm_b32 v52, v101, v97, s64
    v_perm_b32 v101, v101, v97, s65
    v_mov_b32 v97, v52
    v_perm_b32 v52, v102, v98, s64
    v_perm_b32 v102, v102, v98, s65
    v_mov_b32 v98, v52
    v_perm_b32 v52, v103, v99, s64
    v_perm_b32 v103, v103, v99, s65
    v_mov_b32 v99, v52
    s_waitcnt lgkmcnt(0)
    s_mul_i32 s32, s32, 1664525
    s_add_u32 s32, s32, 1013904223
    s_lshl_b32 s71, s73, 8
    s_add_u32 s71, s71, 65536
    s_waitcnt lgkmcnt(0)
    ds_read_b128 v[16:19], v9 offset:0
    ds_read_b128 v[20:23], v9 offset:64
    ds_read_b128 v[24:27], v9 offset:128
    ds_read_b128 v[28:31], v9 offset:192
    ds_read_b128 v[32:35], v9 offset:256
    s_waitcnt lgkmcnt(0)
    v_mfma_f32_16x16x32_bf16 v[104:107], v[16:19], v[64:67], 0
    v_mfma_f32_16x16x32_bf16 v[108:111], v[16:19], v[68:71], 0
    v_mfma_f32_16x16x32_bf16 v[104:107], v[20:23], v[72:75], v[104:107]
    v_mfma_f32_16x16x32_bf16 v[108:111], v[20:23], v[76:79], v[108:111]
    v_mfma_f32_16x16x32_bf16 v[104:107], v[24:27], v[80:83], v[104:107]
    v_mfma_f32_16x16x32_bf16 v[108:111], v[24:27], v[84:87], v[108:111]
    v_mfma_f32_16x16x32_bf16 v[104:107], v[28:31], v[88:91], v[104:107]
    v_mfma_f32_16x16x32_bf16 v[108:111], v[28:31], v[92:95], v[108:111]
    v_mfma_f32_16x16x32_bf16 v[104:107], v[32:35], v[96:99], v[104:107]
    v_mfma_f32_16x16x32_bf16 v[108:111], v[32:35], v[100:103], v[108:111]
    s_lshl_b32 s72, s68, 8
    s_add_u32 s72, s72, 158336
    v_lshl_add_u32 v6, v2, 3, s72
    v_mov_b32 v7, 161920
    v_mov_b32 v20, 1
    s_nop 7
    s_mov_b64 exec, 0xffff
    ds_write2_b32 v6, v104, v108 offset0:0 offset1:1
    ds_write2_b32 v6, v105, v109 offset0:32 offset1:33
    s_waitcnt lgkmcnt(0)
    s_mov_b64 exec, 1
    ds_add_u32 v7, v20
    s_mov_b64 exec, -1
    s_add_u32 s15, s15, 4
    s_cmp_eq_u32 s68, 0
    s_cbranch_scc0 Lpubd_16
    s_mov_b32 s33, 0x40000
Lspin_17:
    ds_read_b32 v20, v7
    s_waitcnt lgkmcnt(0)
    v_readfirstlane_b32 s36, v20
    s_cmp_ge_u32 s36, s15
    s_cbranch_scc1 Lspind_18
    s_sub_u32 s33, s33, 1
    s_cmp_eq_u32 s33, 0
    s_cbranch_scc0 Lspin_17
Lspind_18:
    v_lshlrev_b32 v6, 2, v4
    v_add_u32 v6, 158336, v6
    ds_read_b32 v16, v6 offset:0
    ds_read_b32 v17, v6 offset:128
    ds_read_b32 v18, v6 offset:256
    ds_read_b32 v19, v6 offset:384
    ds_read_b32 v20, v6 offset:512
    ds_read_b32 v21, v6 offset:640
    ds_read_b32 v22, v6 offset:768
    ds_read_b32 v23, v6 offset:896
    s_waitcnt lgkmcnt(0)
    v_add_f32 v16, v16, v18
    v_add_f32 v17, v17, v19
    v_add_f32 v20, v20, v22
    v_add_f32 v21, v21, v23
    v_add_f32 v16, v16, v20
    v_add_f32 v17, v17, v21
    v_cvt_pk_bf16_f32 v16, v16, v17
    v_mov_b32 v17, s32
    v_lshl_add_u32 v6, v4, 3, s71
    s_mov_b32 exec_lo, -1
    s_mov_b32 exec_hi, 0
    buffer_store_dwordx2 v[16:17], v6, s[60:63], 0 offen sc1
    s_mov_b64 exec, -1
Lpubd_16:
    s_branch Lqpoll
Lrole_none:
    s_barrier
    s_waitcnt lgkmcnt(0)
    s_mul_i32 s32, s32, 1664525
    s_add_u32 s32, s32, 1013904223
Lqpoll:
    s_cmp_eq_u32 s68, 1
    s_cbranch_scc0 Lb2
    s_lshr_b32 s71, s2, 3
    s_lshl_b32 s71, s71, 10
    s_add_u32 s71, s71, 131072
    v_lshl_add_u32 v6, v1, 4, s71
    s_mov_b64 s[34:35], exec
    s_mov_b32 s33, 0x8000
Lpoll_19:
    buffer_load_dwordx4 v[16:19], v6, s[60:63], 0 offen sc1
    s_waitcnt vmcnt(0)
    v_cmp_ne_u32 s[38:39], s32, v17
    v_cmp_ne_u32 vcc, s32, v19
    s_or_b64 s[38:39], s[38:39], vcc
    s_and_b64 exec, exec, s[38:39]
    s_cbranch_execz Lpolld_20
    s_sub_u32 s33, s33, 1
    s_cmp_eq_u32 s33, 0
    s_cbranch_scc0 Lpoll_19
Lpolld_20:
    s_mov_b64 exec, s[34:35]
    v_perm_b32 v20, v18, v16, s64
    v_perm_b32 v21, v18, v16, s65
    v_lshlrev_b32 v6, 2, v1
    v_add_u32 v6, 160384, v6
    ds_write_b32 v6, v20
    ds_write_b32 v6, v21 offset:256
    s_waitcnt lgkmcnt(0)
Lb2:
    s_barrier
    s_cmp_ge_u32 s14, 176
    s_cbranch_scc0 Lm2_done
    s_sub_u32 s73, s14, 136
    s_mov_b32 s56, s22
    s_and_b32 s57, s23, 0xffff
    s_mov_b32 s58, 2560
    s_mov_b32 s59, 0x20000
    v_mul_u32_u24 v6, 1280, v5
    s_lshl_b32 s71, s70, 1
    v_add_u32 v6, s71, v6
    v_lshl_add_u32 v7, v10, 2, v6
    buffer_load_dword v26, v7, s[56:59], 0 offen
    v_lshl_add_u32 v7, v11, 2, v6
    buffer_load_dword v27, v7, s[56:59], 0 offen
    v_lshl_add_u32 v7, v12, 2, v6
    buffer_load_dword v28, v7, s[56:59], 0 offen
    s_mov_b32 s56, s24
    s_and_b32 s57, s25, 0xffff
    s_mov_b32 s58, 4915200
    s_mov_b32 s59, 0x20000
    s_lshl_b32 s71, s73, 6
    s_mul_i32 s72, s70, 7680
    s_add_u32 s71, s71, s72
    v_mul_u32_u24 v7, 61440, v3
    v_lshl_add_u32 v7, v2, 2, v7
    v_add_u32 v7, s71, v7
    buffer_load_dword v64, v7, s[56:59], 0 offen offset:0 nt
    s_mov_b32 s36, 7680
    buffer_load_dword v68, v7, s[56:59], s36 offen nt
    s_mov_b32 s36, 15360
    buffer_load_dword v65, v7, s[56:59], s36 offen nt
    s_mov_b32 s36, 23040
    buffer_load_dword v69, v7, s[56:59], s36 offen nt
    s_mov_b32 s36, 30720
    buffer_load_dword v66, v7, s[56:59], s36 offen nt
    s_mov_b32 s36, 38400
    buffer_load_dword v70, v7, s[56:59], s36 offen nt
    s_mov_b32 s36, 46080
    buffer_load_dword v67, v7, s[56:59], s36 offen nt
    s_mov_b32 s36, 53760
    buffer_load_dword v71, v7, s[56:59], s36 offen nt
    s_mov_b32 s36, 245760
    buffer_load_dword v72, v7, s[56:59], s36 offen nt
    s_mov_b32 s36, 253440
    buffer_load_dword v76, v7, s[56:59], s36 offen nt
    s_mov_b32 s36, 261120
    buffer_load_dword v73, v7, s[56:59], s36 offen nt
    s_mov_b32 s36, 268800
    buffer_load_dword v77, v7, s[56:59], s36 offen nt
    s_mov_b32 s36, 276480
    buffer_load_dword v74, v7, s[56:59], s36 offen nt
    s_mov_b32 s36, 284160
    buffer_load_dword v78, v7, s[56:59], s36 offen nt
    s_mov_b32 s36, 291840
    buffer_load_dword v75, v7, s[56:59], s36 offen nt
    s_mov_b32 s36, 299520
    buffer_load_dword v79, v7, s[56:59], s36 offen nt
    s_mov_b32 s36, 491520
    buffer_load_dword v80, v7, s[56:59], s36 offen nt
    s_mov_b32 s36, 499200
    buffer_load_dword v84, v7, s[56:59], s36 offen nt
    s_mov_b32 s36, 506880
    buffer_load_dword v81, v7, s[56:59], s36 offen nt
    s_mov_b32 s36, 514560
    buffer_load_dword v85, v7, s[56:59], s36 offen nt
    s_mov_b32 s36, 522240
    buffer_load_dword v82, v7, s[56:59], s36 offen nt
    s_mov_b32 s36, 529920
    buffer_load_dword v86, v7, s[56:59], s36 offen nt
    s_mov_b32 s36, 537600
    buffer_load_dword v83, v7, s[56:59], s36 offen nt
    s_mov_b32 s36, 545280
    buffer_load_dword v87, v7, s[56:59], s36 offen nt
    s_mov_b32 s36, 737280
    buffer_load_dword v88, v7, s[56:59], s36 offen nt
    s_mov_b32 s36, 744960
    buffer_load_dword v92, v7, s[56:59], s36 offen nt
    s_mov_b32 s36, 752640
    buffer_load_dword v89, v7, s[56:59], s36 offen nt
    s_mov_b32 s36, 760320
    buffer_load_dword v93, v7, s[56:59], s36 offen nt
    s_mov_b32 s36, 768000
    buffer_load_dword v90, v7, s[56:59], s36 offen nt
    s_mov_b32 s36, 775680
    buffer_load_dword v94, v7, s[56:59], s36 offen nt
    s_mov_b32 s36, 783360
    buffer_load_dword v91, v7, s[56:59], s36 offen nt
    s_mov_b32 s36, 791040
    buffer_load_dword v95, v7, s[56:59], s36 offen nt
    s_mov_b32 s36, 983040
    buffer_load_dword v96, v7, s[56:59], s36 offen nt
    s_mov_b32 s36, 990720
    buffer_load_dword v100, v7, s[56:59], s36 offen nt
    s_mov_b32 s36, 998400
    buffer_load_dword v97, v7, s[56:59], s36 offen nt
    s_mov_b32 s36, 1006080
    buffer_load_dword v101, v7, s[56:59], s36 offen nt
    s_mov_b32 s36, 1013760
    buffer_load_dword v98, v7, s[56:59], s36 offen nt
    s_mov_b32 s36, 1021440
    buffer_load_dword v102, v7, s[56:59], s36 offen nt
    s_mov_b32 s36, 1029120
    buffer_load_dword v99, v7, s[56:59], s36 offen nt
    s_mov_b32 s36, 1036800
    buffer_load_dword v103, v7, s[56:59], s36 offen nt
    s_waitcnt vmcnt(40)
    v_lshlrev_b32 v30, 16, v26
    v_and_b32 v31, 0xffff0000, v26
    v_lshlrev_b32 v32, 16, v27
    v_and_b32 v33, 0xffff0000, v27
    v_lshlrev_b32 v34, 16, v28
    v_and_b32 v35, 0xffff0000, v28
    v_mul_f32 v56, s37, v30
    v_exp_f32 v56, v56
    s_nop 0
    v_add_f32 v56, 1.0, v56
    v_rcp_f32 v56, v56
    s_nop 0
    v_mul_f32 v30, v30, v56
    v_mul_f32 v56, s37, v31
    v_exp_f32 v56, v56
    s_nop 0
    v_add_f32 v56, 1.0, v56
    v_rcp_f32 v56, v56
    s_nop 0
    v_mul_f32 v31, v31, v56
    v_mul_f32 v56, s37, v32
    v_exp_f32 v56, v56
    s_nop 0
    v_add_f32 v56, 1.0, v56
    v_rcp_f32 v56, v56
    s_nop 0
    v_mul_f32 v32, v32, v56
    v_mul_f32 v56, s37, v33
    v_exp_f32 v56, v56
    s_nop 0
    v_add_f32 v56, 1.0, v56
    v_rcp_f32 v56, v56
    s_nop 0
    v_mul_f32 v33, v33, v56
    v_mul_f32 v56, s37, v34
    v_exp_f32 v56, v56
    s_nop 0
    v_add_f32 v56, 1.0, v56
    v_rcp_f32 v56, v56
    s_nop 0
    v_mul_f32 v34, v34, v56
    v_mul_f32 v56, s37, v35
    v_exp_f32 v56, v56
    s_nop 0
    v_add_f32 v56, 1.0, v56
    v_rcp_f32 v56, v56
    s_nop 0
    v_mul_f32 v35, v35, v56
    v_cvt_pk_bf16_f32 v30, v30, v31
    ds_write_b32 v13, v30
    v_cvt_pk_bf16_f32 v31, v32, v33
    ds_write_b32 v14, v31
    v_cvt_pk_bf16_f32 v32, v34, v35
    ds_write_b32 v15, v32
    s_waitcnt vmcnt(0)
    v_perm_b32 v52, v68, v64, s64
    v_perm_b32 v68, v68, v64, s65
    v_mov_b32 v64, v52
    v_perm_b32 v52, v69, v65, s64
    v_perm_b32 v69, v69, v65, s65
    v_mov_b32 v65, v52
    v_perm_b32 v52, v70, v66, s64
    v_perm_b32 v70, v70, v66, s65
    v_mov_b32 v66, v52
    v_perm_b32 v52, v71, v67, s64
    v_perm_b32 v71, v71, v67, s65
    v_mov_b32 v67, v52
    v_perm_b32 v52, v76, v72, s64
    v_perm_b32 v76, v76, v72, s65
    v_mov_b32 v72, v52
    v_perm_b32 v52, v77, v73, s64
    v_perm_b32 v77, v77, v73, s65
    v_mov_b32 v73, v52
    v_perm_b32 v52, v78, v74, s64
    v_perm_b32 v78, v78, v74, s65
    v_mov_b32 v74, v52
    v_perm_b32 v52, v79, v75, s64
    v_perm_b32 v79, v79, v75, s65
    v_mov_b32 v75, v52
    v_perm_b32 v52, v84, v80, s64
    v_perm_b32 v84, v84, v80, s65
    v_mov_b32 v80, v52
    v_perm_b32 v52, v85, v81, s64
    v_perm_b32 v85, v85, v81, s65
    v_mov_b32 v81, v52
    v_perm_b32 v52, v86, v82, s64
    v_perm_b32 v86, v86, v82, s65
    v_mov_b32 v82, v52
    v_perm_b32 v52, v87, v83, s64
    v_perm_b32 v87, v87, v83, s65
    v_mov_b32 v83, v52
    v_perm_b32 v52, v92, v88, s64
    v_perm_b32 v92, v92, v88, s65
    v_mov_b32 v88, v52
    v_perm_b32 v52, v93, v89, s64
    v_perm_b32 v93, v93, v89, s65
    v_mov_b32 v89, v52
    v_perm_b32 v52, v94, v90, s64
    v_perm_b32 v94, v94, v90, s65
    v_mov_b32 v90, v52
    v_perm_b32 v52, v95, v91, s64
    v_perm_b32 v95, v95, v91, s65
    v_mov_b32 v91, v52
    v_perm_b32 v52, v100, v96, s64
    v_perm_b32 v100, v100, v96, s65
    v_mov_b32 v96, v52
    v_perm_b32 v52, v101, v97, s64
    v_perm_b32 v101, v101, v97, s65
    v_mov_b32 v97, v52
    v_perm_b32 v52, v102, v98, s64
    v_perm_b32 v102, v102, v98, s65
    v_mov_b32 v98, v52
    v_perm_b32 v52, v103, v99, s64
    v_perm_b32 v103, v103, v99, s65
    v_mov_b32 v99, v52
    s_lshl_b32 s71, s73, 8
    s_add_u32 s71, s71, 65536
    s_waitcnt lgkmcnt(0)
    ds_read_b128 v[16:19], v9 offset:0
    ds_read_b128 v[20:23], v9 offset:64
    ds_read_b128 v[24:27], v9 offset:128
    ds_read_b128 v[28:31], v9 offset:192
    ds_read_b128 v[32:35], v9 offset:256
    s_waitcnt lgkmcnt(0)
    v_mfma_f32_16x16x32_bf16 v[104:107], v[16:19], v[64:67], 0
    v_mfma_f32_16x16x32_bf16 v[108:111], v[16:19], v[68:71], 0
    v_mfma_f32_16x16x32_bf16 v[104:107], v[20:23], v[72:75], v[104:107]
    v_mfma_f32_16x16x32_bf16 v[108:111], v[20:23], v[76:79], v[108:111]
    v_mfma_f32_16x16x32_bf16 v[104:107], v[24:27], v[80:83], v[104:107]
    v_mfma_f32_16x16x32_bf16 v[108:111], v[24:27], v[84:87], v[108:111]
    v_mfma_f32_16x16x32_bf16 v[104:107], v[28:31], v[88:91], v[104:107]
    v_mfma_f32_16x16x32_bf16 v[108:111], v[28:31], v[92:95], v[108:111]
    v_mfma_f32_16x16x32_bf16 v[104:107], v[32:35], v[96:99], v[104:107]
    v_mfma_f32_16x16x32_bf16 v[108:111], v[32:35], v[100:103], v[108:111]
    s_lshl_b32 s72, s68, 8
    s_add_u32 s72, s72, 158336
    v_lshl_add_u32 v6, v2, 3, s72
    v_mov_b32 v7, 161920
    v_mov_b32 v20, 1
    s_nop 7
    s_mov_b64 exec, 0xffff
    ds_write2_b32 v6, v104, v108 offset0:0 offset1:1
    ds_write2_b32 v6, v105, v109 offset0:32 offset1:33
    s_waitcnt lgkmcnt(0)
    s_mov_b64 exec, 1
    ds_add_u32 v7, v20
    s_mov_b64 exec, -1
    s_add_u32 s15, s15, 4
    s_cmp_eq_u32 s68, 0
    s_cbranch_scc0 Lpubd_21
    s_mov_b32 s33, 0x40000
Lspin_22:
    ds_read_b32 v20, v7
    s_waitcnt lgkmcnt(0)
    v_readfirstlane_b32 s36, v20
    s_cmp_ge_u32 s36, s15
    s_cbranch_scc1 Lspind_23
    s_sub_u32 s33, s33, 1
    s_cmp_eq_u32 s33, 0
    s_cbranch_scc0 Lspin_22
Lspind_23:
    v_lshlrev_b32 v6, 2, v4
    v_add_u32 v6, 158336, v6
    ds_read_b32 v16, v6 offset:0
    ds_read_b32 v17, v6 offset:128
    ds_read_b32 v18, v6 offset:256
    ds_read_b32 v19, v6 offset:384
    ds_read_b32 v20, v6 offset:512
    ds_read_b32 v21, v6 offset:640
    ds_read_b32 v22, v6 offset:768
    ds_read_b32 v23, v6 offset:896
    s_waitcnt lgkmcnt(0)
    v_add_f32 v16, v16, v18
    v_add_f32 v17, v17, v19
    v_add_f32 v20, v20, v22
    v_add_f32 v21, v21, v23
    v_add_f32 v16, v16, v20
    v_add_f32 v17, v17, v21
    v_cvt_pk_bf16_f32 v16, v16, v17
    v_mov_b32 v17, s32
    v_lshl_add_u32 v6, v4, 3, s71
    s_mov_b32 exec_lo, -1
    s_mov_b32 exec_hi, 0
    buffer_store_dwordx2 v[16:17], v6, s[60:63], 0 offen sc1
    s_mov_b64 exec, -1
Lpubd_21:
Lm2_done:
    s_cmp_eq_u32 s68, 0
    s_cbranch_scc0 Linv_done
    v_mov_b32 v16, -1
    v_mov_b32 v17, -1
    v_mov_b32 v18, -1
    v_mov_b32 v19, -1
    s_lshr_b32 s71, s2, 3
    s_lshl_b32 s71, s71, 4
    s_and_b32 s72, s2, 7
    s_add_u32 s71, s71, s72
    s_mul_i32 s71, s71, 528
    s_add_u32 s71, s71, 196608
    v_lshl_add_u32 v6, v1, 4, s71
    v_cmp_gt_u32 vcc, 33, v1
    s_and_b64 exec, exec, vcc
    buffer_store_dwordx4 v[16:19], v6, s[60:63], 0 offen sc1
    s_movk_i32 s36, 4224
    buffer_store_dwordx4 v[16:19], v6, s[60:63], s36 offen sc1
    s_mov_b64 exec, -1
    s_cmp_lt_u32 s14, 80
    s_cbranch_scc0 Linv_b
    s_mul_i32 s71, s14, 205
    s_lshr_b32 s71, s71, 11
    s_mul_i32 s72, s71, 10
    s_sub_u32 s72, s14, s72
    s_mul_i32 s71, s71, 5120
    s_lshl_b32 s72, s72, 8
    s_add_u32 s71, s71, s72
    s_add_u32 s71, s71, 524288
    v_lshrrev_b32 v6, 4, v1
    v_mul_u32_u24 v6, 2560, v6
    v_lshl_add_u32 v6, v2, 4, v6
    v_add_u32 v6, s71, v6
    s_mov_b32 exec_lo, -1
    s_mov_b32 exec_hi, 0
    buffer_store_dwordx4 v[16:19], v6, s[60:63], 0 offen sc1
    s_mov_b64 exec, -1
    s_branch Linv_c
Linv_b:
    s_cmp_lt_u32 s14, 134
    s_cbranch_scc0 Linv_c
    s_sub_u32 s71, s14, 80
    s_mul_i32 s71, s71, 5120
    s_add_u32 s71, s71, 589824
    v_lshl_add_u32 v6, v1, 4, s71
    s_movk_i32 s36, 0
    buffer_store_dwordx4 v[16:19], v6, s[60:63], s36 offen sc1
    s_movk_i32 s36, 1024
    buffer_store_dwordx4 v[16:19], v6, s[60:63], s36 offen sc1
    s_movk_i32 s36, 2048
    buffer_store_dwordx4 v[16:19], v6, s[60:63], s36 offen sc1
    s_movk_i32 s36, 3072
    buffer_store_dwordx4 v[16:19], v6, s[60:63], s36 offen sc1
    s_movk_i32 s36, 4096
    buffer_store_dwordx4 v[16:19], v6, s[60:63], s36 offen sc1
Linv_c:
    s_and_b32 s71, s2, 7
    s_cmp_eq_u32 s71, 0
    s_cbranch_scc0 Linv_e
    s_lshr_b32 s71, s2, 3
    s_lshl_b32 s71, s71, 8
    s_add_u32 s71, s71, 917504
    v_mov_b32 v6, s71
    v_mov_b32 v7, 0
    s_mov_b64 exec, 1
    buffer_store_dword v7, v6, s[60:63], 0 offen sc1
    s_mov_b64 exec, -1
Linv_e:
    s_waitcnt vmcnt(0)
    v_mov_b32 v6, 0
    v_mov_b32 v7, 1
    s_mov_b64 exec, 1
    global_atomic_add v6, v7, s[28:29] sc1
    s_mov_b64 exec, -1
Linv_done:
    s_barrier
    s_cmp_eq_u32 s68, 0
    s_cbranch_scc0 Larr_done
    v_mov_b32 v6, 0
    s_mov_b64 s[34:35], exec
    s_mov_b32 s33, 0x8000
Lpoll_24:
    global_load_dword v16, v6, s[28:29] sc1
    s_waitcnt vmcnt(0)
    v_cmp_ne_u32 vcc, 0x100, v16
    s_mov_b64 s[38:39], vcc
    s_and_b64 exec, exec, s[38:39]
    s_cbranch_execz Lpolld_25
    s_sub_u32 s33, s33, 1
    s_cmp_eq_u32 s33, 0
    s_cbranch_scc0 Lpoll_24
Lpolld_25:
    s_mov_b64 exec, s[34:35]
    v_mov_b32 v6, 161920
    v_mov_b32 v7, 1
    ds_write_b32 v6, v7 offset:4
    s_waitcnt lgkmcnt(0)
Larr_done:
    s_cmp_lt_u32 s14, 80
    s_cbranch_scc1 Lpre_o
    s_cmp_lt_u32 s14, 134
    s_cbranch_scc1 Lpre_f
    s_cmp_lt_u32 s14, 174
    s_cbranch_scc1 Lpre_z
    s_branch Lpre_done
Lpre_o:
    s_mul_i32 s72, s14, 205
    s_lshr_b32 s72, s72, 11
    s_mul_i32 s73, s72, 10
    s_sub_u32 s73, s14, s73
    s_mov_b32 s56, s12
    s_and_b32 s57, s13, 0xffff
    s_mov_b32 s58, 5242880
    s_mov_b32 s59, 0x20000
    s_lshl_b32 s71, s72, 2
    s_add_u32 s71, s71, s68
    s_mul_i32 s74, s71, 163840
    s_lshl_b32 s75, s73, 7
    s_add_u32 s74, s74, s75
    v_mul_u32_u24 v7, 10240, v3
    v_lshl_add_u32 v7, v2, 3, v7
    v_add_u32 v7, s74, v7
    buffer_load_dwordx2 v[192:193], v7, s[56:59], 0 offen offset:0 sc1 nt
    buffer_load_dwordx2 v[194:195], v7, s[56:59], 0 offen offset:1280 sc1 nt
    buffer_load_dwordx2 v[196:197], v7, s[56:59], 0 offen offset:2560 sc1 nt
    buffer_load_dwordx2 v[198:199], v7, s[56:59], 0 offen offset:3840 sc1 nt
    s_mov_b32 s36, 5120
    buffer_load_dwordx2 v[200:201], v7, s[56:59], s36 offen sc1 nt
    s_mov_b32 s36, 6400
    buffer_load_dwordx2 v[202:203], v7, s[56:59], s36 offen sc1 nt
    s_mov_b32 s36, 7680
    buffer_load_dwordx2 v[204:205], v7, s[56:59], s36 offen sc1 nt
    s_mov_b32 s36, 8960
    buffer_load_dwordx2 v[206:207], v7, s[56:59], s36 offen sc1 nt
    s_mov_b32 s36, 40960
    buffer_load_dwordx2 v[208:209], v7, s[56:59], s36 offen sc1 nt
    s_mov_b32 s36, 42240
    buffer_load_dwordx2 v[210:211], v7, s[56:59], s36 offen sc1 nt
    s_mov_b32 s36, 43520
    buffer_load_dwordx2 v[212:213], v7, s[56:59], s36 offen sc1 nt
    s_mov_b32 s36, 44800
    buffer_load_dwordx2 v[214:215], v7, s[56:59], s36 offen sc1 nt
    s_mov_b32 s36, 46080
    buffer_load_dwordx2 v[216:217], v7, s[56:59], s36 offen sc1 nt
    s_mov_b32 s36, 47360
    buffer_load_dwordx2 v[218:219], v7, s[56:59], s36 offen sc1 nt
    s_mov_b32 s36, 48640
    buffer_load_dwordx2 v[220:221], v7, s[56:59], s36 offen sc1 nt
    s_mov_b32 s36, 49920
    buffer_load_dwordx2 v[222:223], v7, s[56:59], s36 offen sc1 nt
    s_mov_b32 s36, 81920
    buffer_load_dwordx2 v[224:225], v7, s[56:59], s36 offen sc1 nt
    s_mov_b32 s36, 83200
    buffer_load_dwordx2 v[226:227], v7, s[56:59], s36 offen sc1 nt
    s_mov_b32 s36, 84480
    buffer_load_dwordx2 v[228:229], v7, s[56:59], s36 offen sc1 nt
    s_mov_b32 s36, 85760
    buffer_load_dwordx2 v[230:231], v7, s[56:59], s36 offen sc1 nt
    s_mov_b32 s36, 87040
    buffer_load_dwordx2 v[232:233], v7, s[56:59], s36 offen sc1 nt
    s_mov_b32 s36, 88320
    buffer_load_dwordx2 v[234:235], v7, s[56:59], s36 offen sc1 nt
    s_mov_b32 s36, 89600
    buffer_load_dwordx2 v[236:237], v7, s[56:59], s36 offen sc1 nt
    s_mov_b32 s36, 90880
    buffer_load_dwordx2 v[238:239], v7, s[56:59], s36 offen sc1 nt
    s_mov_b32 s36, 122880
    buffer_load_dwordx2 v[240:241], v7, s[56:59], s36 offen sc1 nt
    s_mov_b32 s36, 124160
    buffer_load_dwordx2 v[242:243], v7, s[56:59], s36 offen sc1 nt
    s_mov_b32 s36, 125440
    buffer_load_dwordx2 v[244:245], v7, s[56:59], s36 offen sc1 nt
    s_mov_b32 s36, 126720
    buffer_load_dwordx2 v[246:247], v7, s[56:59], s36 offen sc1 nt
    s_mov_b32 s36, 128000
    buffer_load_dwordx2 v[248:249], v7, s[56:59], s36 offen sc1 nt
    s_mov_b32 s36, 129280
    buffer_load_dwordx2 v[250:251], v7, s[56:59], s36 offen sc1 nt
    s_mov_b32 s36, 130560
    buffer_load_dwordx2 v[252:253], v7, s[56:59], s36 offen sc1 nt
    s_mov_b32 s36, 131840
    buffer_load_dwordx2 v[254:255], v7, s[56:59], s36 offen sc1 nt
    s_waitcnt vmcnt(0)
    v_perm_b32 v128, v194, v192, s64
    v_perm_b32 v132, v194, v192, s65
    v_perm_b32 v160, v195, v193, s64
    v_perm_b32 v164, v195, v193, s65
    v_perm_b32 v129, v198, v196, s64
    v_perm_b32 v133, v198, v196, s65
    v_perm_b32 v161, v199, v197, s64
    v_perm_b32 v165, v199, v197, s65
    v_perm_b32 v130, v202, v200, s64
    v_perm_b32 v134, v202, v200, s65
    v_perm_b32 v162, v203, v201, s64
    v_perm_b32 v166, v203, v201, s65
    v_perm_b32 v131, v206, v204, s64
    v_perm_b32 v135, v206, v204, s65
    v_perm_b32 v163, v207, v205, s64
    v_perm_b32 v167, v207, v205, s65
    v_perm_b32 v136, v210, v208, s64
    v_perm_b32 v140, v210, v208, s65
    v_perm_b32 v168, v211, v209, s64
    v_perm_b32 v172, v211, v209, s65
    v_perm_b32 v137, v214, v212, s64
    v_perm_b32 v141, v214, v212, s65
    v_perm_b32 v169, v215, v213, s64
    v_perm_b32 v173, v215, v213, s65
    v_perm_b32 v138, v218, v216, s64
    v_perm_b32 v142, v218, v216, s65
    v_perm_b32 v170, v219, v217, s64
    v_perm_b32 v174, v219, v217, s65
    v_perm_b32 v139, v222, v220, s64
    v_perm_b32 v143, v222, v220, s65
    v_perm_b32 v171, v223, v221, s64
    v_perm_b32 v175, v223, v221, s65
    v_perm_b32 v144, v226, v224, s64
    v_perm_b32 v148, v226, v224, s65
    v_perm_b32 v176, v227, v225, s64
    v_perm_b32 v180, v227, v225, s65
    v_perm_b32 v145, v230, v228, s64
    v_perm_b32 v149, v230, v228, s65
    v_perm_b32 v177, v231, v229, s64
    v_perm_b32 v181, v231, v229, s65
    v_perm_b32 v146, v234, v232, s64
    v_perm_b32 v150, v234, v232, s65
    v_perm_b32 v178, v235, v233, s64
    v_perm_b32 v182, v235, v233, s65
    v_perm_b32 v147, v238, v236, s64
    v_perm_b32 v151, v238, v236, s65
    v_perm_b32 v179, v239, v237, s64
    v_perm_b32 v183, v239, v237, s65
    v_perm_b32 v152, v242, v240, s64
    v_perm_b32 v156, v242, v240, s65
    v_perm_b32 v184, v243, v241, s64
    v_perm_b32 v188, v243, v241, s65
    v_perm_b32 v153, v246, v244, s64
    v_perm_b32 v157, v246, v244, s65
    v_perm_b32 v185, v247, v245, s64
    v_perm_b32 v189, v247, v245, s65
    v_perm_b32 v154, v250, v248, s64
    v_perm_b32 v158, v250, v248, s65
    v_perm_b32 v186, v251, v249, s64
    v_perm_b32 v190, v251, v249, s65
    v_perm_b32 v155, v254, v252, s64
    v_perm_b32 v159, v254, v252, s65
    v_perm_b32 v187, v255, v253, s64
    v_perm_b32 v191, v255, v253, s65
    s_branch Lpre_done
Lpre_f:
    s_sub_u32 s72, s14, 80
    s_mov_b32 s56, s16
    s_and_b32 s57, s17, 0xffff
    s_mov_b32 s58, 2211840
    s_mov_b32 s59, 0x20000
    s_mul_i32 s71, s70, 3456
    s_lshl_b32 s73, s72, 6
    s_add_u32 s71, s71, s73
    v_mul_u32_u24 v7, 27648, v3
    v_lshl_add_u32 v7, v2, 2, v7
    v_add_u32 v7, s71, v7
    buffer_load_dword v128, v7, s[56:59], 0 offen offset:0 sc1 nt
    buffer_load_dword v132, v7, s[56:59], 0 offen offset:3456 sc1 nt
    s_mov_b32 s36, 6912
    buffer_load_dword v129, v7, s[56:59], s36 offen sc1 nt
    s_mov_b32 s36, 10368
    buffer_load_dword v133, v7, s[56:59], s36 offen sc1 nt
    s_mov_b32 s36, 13824
    buffer_load_dword v130, v7, s[56:59], s36 offen sc1 nt
    s_mov_b32 s36, 17280
    buffer_load_dword v134, v7, s[56:59], s36 offen sc1 nt
    s_mov_b32 s36, 20736
    buffer_load_dword v131, v7, s[56:59], s36 offen sc1 nt
    s_mov_b32 s36, 24192
    buffer_load_dword v135, v7, s[56:59], s36 offen sc1 nt
    s_mov_b32 s36, 110592
    buffer_load_dword v136, v7, s[56:59], s36 offen sc1 nt
    s_mov_b32 s36, 114048
    buffer_load_dword v140, v7, s[56:59], s36 offen sc1 nt
    s_mov_b32 s36, 117504
    buffer_load_dword v137, v7, s[56:59], s36 offen sc1 nt
    s_mov_b32 s36, 120960
    buffer_load_dword v141, v7, s[56:59], s36 offen sc1 nt
    s_mov_b32 s36, 124416
    buffer_load_dword v138, v7, s[56:59], s36 offen sc1 nt
    s_mov_b32 s36, 127872
    buffer_load_dword v142, v7, s[56:59], s36 offen sc1 nt
    s_mov_b32 s36, 131328
    buffer_load_dword v139, v7, s[56:59], s36 offen sc1 nt
    s_mov_b32 s36, 134784
    buffer_load_dword v143, v7, s[56:59], s36 offen sc1 nt
    s_mov_b32 s36, 221184
    buffer_load_dword v144, v7, s[56:59], s36 offen sc1 nt
    s_mov_b32 s36, 224640
    buffer_load_dword v148, v7, s[56:59], s36 offen sc1 nt
    s_mov_b32 s36, 228096
    buffer_load_dword v145, v7, s[56:59], s36 offen sc1 nt
    s_mov_b32 s36, 231552
    buffer_load_dword v149, v7, s[56:59], s36 offen sc1 nt
    s_mov_b32 s36, 235008
    buffer_load_dword v146, v7, s[56:59], s36 offen sc1 nt
    s_mov_b32 s36, 238464
    buffer_load_dword v150, v7, s[56:59], s36 offen sc1 nt
    s_mov_b32 s36, 241920
    buffer_load_dword v147, v7, s[56:59], s36 offen sc1 nt
    s_mov_b32 s36, 245376
    buffer_load_dword v151, v7, s[56:59], s36 offen sc1 nt
    s_mov_b32 s36, 331776
    buffer_load_dword v152, v7, s[56:59], s36 offen sc1 nt
    s_mov_b32 s36, 335232
    buffer_load_dword v156, v7, s[56:59], s36 offen sc1 nt
    s_mov_b32 s36, 338688
    buffer_load_dword v153, v7, s[56:59], s36 offen sc1 nt
    s_mov_b32 s36, 342144
    buffer_load_dword v157, v7, s[56:59], s36 offen sc1 nt
    s_mov_b32 s36, 345600
    buffer_load_dword v154, v7, s[56:59], s36 offen sc1 nt
    s_mov_b32 s36, 349056
    buffer_load_dword v158, v7, s[56:59], s36 offen sc1 nt
    s_mov_b32 s36, 352512
    buffer_load_dword v155, v7, s[56:59], s36 offen sc1 nt
    s_mov_b32 s36, 355968
    buffer_load_dword v159, v7, s[56:59], s36 offen sc1 nt
    s_mov_b32 s36, 442368
    buffer_load_dword v160, v7, s[56:59], s36 offen sc1 nt
    s_mov_b32 s36, 445824
    buffer_load_dword v164, v7, s[56:59], s36 offen sc1 nt
    s_mov_b32 s36, 449280
    buffer_load_dword v161, v7, s[56:59], s36 offen sc1 nt
    s_mov_b32 s36, 452736
    buffer_load_dword v165, v7, s[56:59], s36 offen sc1 nt
    s_mov_b32 s36, 456192
    buffer_load_dword v162, v7, s[56:59], s36 offen sc1 nt
    s_mov_b32 s36, 459648
    buffer_load_dword v166, v7, s[56:59], s36 offen sc1 nt
    s_mov_b32 s36, 463104
    buffer_load_dword v163, v7, s[56:59], s36 offen sc1 nt
    s_mov_b32 s36, 466560
    buffer_load_dword v167, v7, s[56:59], s36 offen sc1 nt
    s_mov_b32 s56, s18
    s_and_b32 s57, s19, 0xffff
    s_mov_b32 s58, 2211840
    s_mov_b32 s59, 0x20000
    s_mul_i32 s71, s70, 3456
    s_lshl_b32 s73, s72, 6
    s_add_u32 s71, s71, s73
    v_mul_u32_u24 v7, 27648, v3
    v_lshl_add_u32 v7, v2, 2, v7
    v_add_u32 v7, s71, v7
    buffer_load_dword v168, v7, s[56:59], 0 offen offset:0 sc1 nt
    buffer_load_dword v172, v7, s[56:59], 0 offen offset:3456 sc1 nt
    s_mov_b32 s36, 6912
    buffer_load_dword v169, v7, s[56:59], s36 offen sc1 nt
    s_mov_b32 s36, 10368
    buffer_load_dword v173, v7, s[56:59], s36 offen sc1 nt
    s_mov_b32 s36, 13824
    buffer_load_dword v170, v7, s[56:59], s36 offen sc1 nt
    s_mov_b32 s36, 17280
    buffer_load_dword v174, v7, s[56:59], s36 offen sc1 nt
    s_mov_b32 s36, 20736
    buffer_load_dword v171, v7, s[56:59], s36 offen sc1 nt
    s_mov_b32 s36, 24192
    buffer_load_dword v175, v7, s[56:59], s36 offen sc1 nt
    s_mov_b32 s36, 110592
    buffer_load_dword v176, v7, s[56:59], s36 offen sc1 nt
    s_mov_b32 s36, 114048
    buffer_load_dword v180, v7, s[56:59], s36 offen sc1 nt
    s_mov_b32 s36, 117504
    buffer_load_dword v177, v7, s[56:59], s36 offen sc1 nt
    s_mov_b32 s36, 120960
    buffer_load_dword v181, v7, s[56:59], s36 offen sc1 nt
    s_mov_b32 s36, 124416
    buffer_load_dword v178, v7, s[56:59], s36 offen sc1 nt
    s_mov_b32 s36, 127872
    buffer_load_dword v182, v7, s[56:59], s36 offen sc1 nt
    s_mov_b32 s36, 131328
    buffer_load_dword v179, v7, s[56:59], s36 offen sc1 nt
    s_mov_b32 s36, 134784
    buffer_load_dword v183, v7, s[56:59], s36 offen sc1 nt
    s_mov_b32 s36, 221184
    buffer_load_dword v184, v7, s[56:59], s36 offen sc1 nt
    s_mov_b32 s36, 224640
    buffer_load_dword v188, v7, s[56:59], s36 offen sc1 nt
    s_mov_b32 s36, 228096
    buffer_load_dword v185, v7, s[56:59], s36 offen sc1 nt
    s_mov_b32 s36, 231552
    buffer_load_dword v189, v7, s[56:59], s36 offen sc1 nt
    s_mov_b32 s36, 235008
    buffer_load_dword v186, v7, s[56:59], s36 offen sc1 nt
    s_mov_b32 s36, 238464
    buffer_load_dword v190, v7, s[56:59], s36 offen sc1 nt
    s_mov_b32 s36, 241920
    buffer_load_dword v187, v7, s[56:59], s36 offen sc1 nt
    s_mov_b32 s36, 245376
    buffer_load_dword v191, v7, s[56:59], s36 offen sc1 nt
    s_mov_b32 s36, 331776
    buffer_load_dword v192, v7, s[56:59], s36 offen sc1 nt
    s_mov_b32 s36, 335232
    buffer_load_dword v196, v7, s[56:59], s36 offen sc1 nt
    s_mov_b32 s36, 338688
    buffer_load_dword v193, v7, s[56:59], s36 offen sc1 nt
    s_mov_b32 s36, 342144
    buffer_load_dword v197, v7, s[56:59], s36 offen sc1 nt
    s_mov_b32 s36, 345600
    buffer_load_dword v194, v7, s[56:59], s36 offen sc1 nt
    s_mov_b32 s36, 349056
    buffer_load_dword v198, v7, s[56:59], s36 offen sc1 nt
    s_mov_b32 s36, 352512
    buffer_load_dword v195, v7, s[56:59], s36 offen sc1 nt
    s_mov_b32 s36, 355968
    buffer_load_dword v199, v7, s[56:59], s36 offen sc1 nt
    s_mov_b32 s36, 442368
    buffer_load_dword v200, v7, s[56:59], s36 offen sc1 nt
    s_mov_b32 s36, 445824
    buffer_load_dword v204, v7, s[56:59], s36 offen sc1 nt
    s_mov_b32 s36, 449280
    buffer_load_dword v201, v7, s[56:59], s36 offen sc1 nt
    s_mov_b32 s36, 452736
    buffer_load_dword v205, v7, s[56:59], s36 offen sc1 nt
    s_mov_b32 s36, 456192
    buffer_load_dword v202, v7, s[56:59], s36 offen sc1 nt
    s_mov_b32 s36, 459648
    buffer_load_dword v206, v7, s[56:59], s36 offen sc1 nt
    s_mov_b32 s36, 463104
    buffer_load_dword v203, v7, s[56:59], s36 offen sc1 nt
    s_mov_b32 s36, 466560
    buffer_load_dword v207, v7, s[56:59], s36 offen sc1 nt
    s_mov_b32 s56, s20
    s_and_b32 s57, s21, 0xffff
    s_mov_b32 s58, 2211840
    s_mov_b32 s59, 0x20000
    s_mul_i32 s71, s72, 40960
    s_mul_i32 s73, s68, 320
    s_add_u32 s71, s71, s73
    v_mul_u32_u24 v7, 10240, v3
    v_lshl_add_u32 v7, v2, 2, v7
    v_add_u32 v7, s71, v7
    buffer_load_dword v208, v7, s[56:59], 0 offen offset:0 sc1 nt
    buffer_load_dword v212, v7, s[56:59], 0 offen offset:1280 sc1 nt
    buffer_load_dword v209, v7, s[56:59], 0 offen offset:2560 sc1 nt
    buffer_load_dword v213, v7, s[56:59], 0 offen offset:3840 sc1 nt
    s_mov_b32 s36, 5120
    buffer_load_dword v210, v7, s[56:59], s36 offen sc1 nt
    s_mov_b32 s36, 6400
    buffer_load_dword v214, v7, s[56:59], s36 offen sc1 nt
    s_mov_b32 s36, 7680
    buffer_load_dword v211, v7, s[56:59], s36 offen sc1 nt
    s_mov_b32 s36, 8960
    buffer_load_dword v215, v7, s[56:59], s36 offen sc1 nt
    buffer_load_dword v216, v7, s[56:59], 0 offen offset:64 sc1 nt
    buffer_load_dword v220, v7, s[56:59], 0 offen offset:1344 sc1 nt
    buffer_load_dword v217, v7, s[56:59], 0 offen offset:2624 sc1 nt
    buffer_load_dword v221, v7, s[56:59], 0 offen offset:3904 sc1 nt
    s_mov_b32 s36, 5184
    buffer_load_dword v218, v7, s[56:59], s36 offen sc1 nt
    s_mov_b32 s36, 6464
    buffer_load_dword v222, v7, s[56:59], s36 offen sc1 nt
    s_mov_b32 s36, 7744
    buffer_load_dword v219, v7, s[56:59], s36 offen sc1 nt
    s_mov_b32 s36, 9024
    buffer_load_dword v223, v7, s[56:59], s36 offen sc1 nt
    buffer_load_dword v224, v7, s[56:59], 0 offen offset:128 sc1 nt
    buffer_load_dword v228, v7, s[56:59], 0 offen offset:1408 sc1 nt
    buffer_load_dword v225, v7, s[56:59], 0 offen offset:2688 sc1 nt
    buffer_load_dword v229, v7, s[56:59], 0 offen offset:3968 sc1 nt
    s_mov_b32 s36, 5248
    buffer_load_dword v226, v7, s[56:59], s36 offen sc1 nt
    s_mov_b32 s36, 6528
    buffer_load_dword v230, v7, s[56:59], s36 offen sc1 nt
    s_mov_b32 s36, 7808
    buffer_load_dword v227, v7, s[56:59], s36 offen sc1 nt
    s_mov_b32 s36, 9088
    buffer_load_dword v231, v7, s[56:59], s36 offen sc1 nt
    buffer_load_dword v232, v7, s[56:59], 0 offen offset:192 sc1 nt
    buffer_load_dword v236, v7, s[56:59], 0 offen offset:1472 sc1 nt
    buffer_load_dword v233, v7, s[56:59], 0 offen offset:2752 sc1 nt
    buffer_load_dword v237, v7, s[56:59], 0 offen offset:4032 sc1 nt
    s_mov_b32 s36, 5312
    buffer_load_dword v234, v7, s[56:59], s36 offen sc1 nt
    s_mov_b32 s36, 6592
    buffer_load_dword v238, v7, s[56:59], s36 offen sc1 nt
    s_mov_b32 s36, 7872
    buffer_load_dword v235, v7, s[56:59], s36 offen sc1 nt
    s_mov_b32 s36, 9152
    buffer_load_dword v239, v7, s[56:59], s36 offen sc1 nt
    buffer_load_dword v240, v7, s[56:59], 0 offen offset:256 sc1 nt
    buffer_load_dword v244, v7, s[56:59], 0 offen offset:1536 sc1 nt
    buffer_load_dword v241, v7, s[56:59], 0 offen offset:2816 sc1 nt
    s_mov_b32 s36, 4096
    buffer_load_dword v245, v7, s[56:59], s36 offen sc1 nt
    s_mov_b32 s36, 5376
    buffer_load_dword v242, v7, s[56:59], s36 offen sc1 nt
    s_mov_b32 s36, 6656
    buffer_load_dword v246, v7, s[56:59], s36 offen sc1 nt
    s_mov_b32 s36, 7936
    buffer_load_dword v243, v7, s[56:59], s36 offen sc1 nt
    s_mov_b32 s36, 9216
    buffer_load_dword v247, v7, s[56:59], s36 offen sc1 nt
    s_mov_b32 s56, s4
    s_and_b32 s57, s5, 0xffff
    s_mov_b32 s58, 2560
    s_mov_b32 s59, 0x20000
    v_mul_u32_u24 v6, 1280, v5
    s_lshl_b32 s71, s70, 1
    v_add_u32 v6, s71, v6
    v_lshl_add_u32 v7, v10, 2, v6
    buffer_load_dword v26, v7, s[56:59], 0 offen
    v_lshl_add_u32 v7, v11, 2, v6
    buffer_load_dword v27, v7, s[56:59], 0 offen
    v_lshl_add_u32 v7, v12, 2, v6
    buffer_load_dword v28, v7, s[56:59], 0 offen
    s_waitcnt vmcnt(0)
    v_perm_b32 v52, v132, v128, s64
    v_perm_b32 v132, v132, v128, s65
    v_mov_b32 v128, v52
    v_perm_b32 v52, v133, v129, s64
    v_perm_b32 v133, v133, v129, s65
    v_mov_b32 v129, v52
    v_perm_b32 v52, v134, v130, s64
    v_perm_b32 v134, v134, v130, s65
    v_mov_b32 v130, v52
    v_perm_b32 v52, v135, v131, s64
    v_perm_b32 v135, v135, v131, s65
    v_mov_b32 v131, v52
    v_perm_b32 v52, v140, v136, s64
    v_perm_b32 v140, v140, v136, s65
    v_mov_b32 v136, v52
    v_perm_b32 v52, v141, v137, s64
    v_perm_b32 v141, v141, v137, s65
    v_mov_b32 v137, v52
    v_perm_b32 v52, v142, v138, s64
    v_perm_b32 v142, v142, v138, s65
    v_mov_b32 v138, v52
    v_perm_b32 v52, v143, v139, s64
    v_perm_b32 v143, v143, v139, s65
    v_mov_b32 v139, v52
    v_perm_b32 v52, v148, v144, s64
    v_perm_b32 v148, v148, v144, s65
    v_mov_b32 v144, v52
    v_perm_b32 v52, v149, v145, s64
    v_perm_b32 v149, v149, v145, s65
    v_mov_b32 v145, v52
    v_perm_b32 v52, v150, v146, s64
    v_perm_b32 v150, v150, v146, s65
    v_mov_b32 v146, v52
    v_perm_b32 v52, v151, v147, s64
    v_perm_b32 v151, v151, v147, s65
    v_mov_b32 v147, v52
    v_perm_b32 v52, v156, v152, s64
    v_perm_b32 v156, v156, v152, s65
    v_mov_b32 v152, v52
    v_perm_b32 v52, v157, v153, s64
    v_perm_b32 v157, v157, v153, s65
    v_mov_b32 v153, v52
    v_perm_b32 v52, v158, v154, s64
    v_perm_b32 v158, v158, v154, s65
    v_mov_b32 v154, v52
    v_perm_b32 v52, v159, v155, s64
    v_perm_b32 v159, v159, v155, s65
    v_mov_b32 v155, v52
    v_perm_b32 v52, v164, v160, s64
    v_perm_b32 v164, v164, v160, s65
    v_mov_b32 v160, v52
    v_perm_b32 v52, v165, v161, s64
    v_perm_b32 v165, v165, v161, s65
    v_mov_b32 v161, v52
    v_perm_b32 v52, v166, v162, s64
    v_perm_b32 v166, v166, v162, s65
    v_mov_b32 v162, v52
    v_perm_b32 v52, v167, v163, s64
    v_perm_b32 v167, v167, v163, s65
    v_mov_b32 v163, v52
    v_perm_b32 v52, v172, v168, s64
    v_perm_b32 v172, v172, v168, s65
    v_mov_b32 v168, v52
    v_perm_b32 v52, v173, v169, s64
    v_perm_b32 v173, v173, v169, s65
    v_mov_b32 v169, v52
    v_perm_b32 v52, v174, v170, s64
    v_perm_b32 v174, v174, v170, s65
    v_mov_b32 v170, v52
    v_perm_b32 v52, v175, v171, s64
    v_perm_b32 v175, v175, v171, s65
    v_mov_b32 v171, v52
    v_perm_b32 v52, v180, v176, s64
    v_perm_b32 v180, v180, v176, s65
    v_mov_b32 v176, v52
    v_perm_b32 v52, v181, v177, s64
    v_perm_b32 v181, v181, v177, s65
    v_mov_b32 v177, v52
    v_perm_b32 v52, v182, v178, s64
    v_perm_b32 v182, v182, v178, s65
    v_mov_b32 v178, v52
    v_perm_b32 v52, v183, v179, s64
    v_perm_b32 v183, v183, v179, s65
    v_mov_b32 v179, v52
    v_perm_b32 v52, v188, v184, s64
    v_perm_b32 v188, v188, v184, s65
    v_mov_b32 v184, v52
    v_perm_b32 v52, v189, v185, s64
    v_perm_b32 v189, v189, v185, s65
    v_mov_b32 v185, v52
    v_perm_b32 v52, v190, v186, s64
    v_perm_b32 v190, v190, v186, s65
    v_mov_b32 v186, v52
    v_perm_b32 v52, v191, v187, s64
    v_perm_b32 v191, v191, v187, s65
    v_mov_b32 v187, v52
    v_perm_b32 v52, v196, v192, s64
    v_perm_b32 v196, v196, v192, s65
    v_mov_b32 v192, v52
    v_perm_b32 v52, v197, v193, s64
    v_perm_b32 v197, v197, v193, s65
    v_mov_b32 v193, v52
    v_perm_b32 v52, v198, v194, s64
    v_perm_b32 v198, v198, v194, s65
    v_mov_b32 v194, v52
    v_perm_b32 v52, v199, v195, s64
    v_perm_b32 v199, v199, v195, s65
    v_mov_b32 v195, v52
    v_perm_b32 v52, v204, v200, s64
    v_perm_b32 v204, v204, v200, s65
    v_mov_b32 v200, v52
    v_perm_b32 v52, v205, v201, s64
    v_perm_b32 v205, v205, v201, s65
    v_mov_b32 v201, v52
    v_perm_b32 v52, v206, v202, s64
    v_perm_b32 v206, v206, v202, s65
    v_mov_b32 v202, v52
    v_perm_b32 v52, v207, v203, s64
    v_perm_b32 v207, v207, v203, s65
    v_mov_b32 v203, v52
    v_perm_b32 v52, v212, v208, s64
    v_perm_b32 v212, v212, v208, s65
    v_mov_b32 v208, v52
    v_perm_b32 v52, v213, v209, s64
    v_perm_b32 v213, v213, v209, s65
    v_mov_b32 v209, v52
    v_perm_b32 v52, v214, v210, s64
    v_perm_b32 v214, v214, v210, s65
    v_mov_b32 v210, v52
    v_perm_b32 v52, v215, v211, s64
    v_perm_b32 v215, v215, v211, s65
    v_mov_b32 v211, v52
    v_perm_b32 v52, v220, v216, s64
    v_perm_b32 v220, v220, v216, s65
    v_mov_b32 v216, v52
    v_perm_b32 v52, v221, v217, s64
    v_perm_b32 v221, v221, v217, s65
    v_mov_b32 v217, v52
    v_perm_b32 v52, v222, v218, s64
    v_perm_b32 v222, v222, v218, s65
    v_mov_b32 v218, v52
    v_perm_b32 v52, v223, v219, s64
    v_perm_b32 v223, v223, v219, s65
    v_mov_b32 v219, v52
    v_perm_b32 v52, v228, v224, s64
    v_perm_b32 v228, v228, v224, s65
    v_mov_b32 v224, v52
    v_perm_b32 v52, v229, v225, s64
    v_perm_b32 v229, v229, v225, s65
    v_mov_b32 v225, v52
    v_perm_b32 v52, v230, v226, s64
    v_perm_b32 v230, v230, v226, s65
    v_mov_b32 v226, v52
    v_perm_b32 v52, v231, v227, s64
    v_perm_b32 v231, v231, v227, s65
    v_mov_b32 v227, v52
    v_perm_b32 v52, v236, v232, s64
    v_perm_b32 v236, v236, v232, s65
    v_mov_b32 v232, v52
    v_perm_b32 v52, v237, v233, s64
    v_perm_b32 v237, v237, v233, s65
    v_mov_b32 v233, v52
    v_perm_b32 v52, v238, v234, s64
    v_perm_b32 v238, v238, v234, s65
    v_mov_b32 v234, v52
    v_perm_b32 v52, v239, v235, s64
    v_perm_b32 v239, v239, v235, s65
    v_mov_b32 v235, v52
    v_perm_b32 v52, v244, v240, s64
    v_perm_b32 v244, v244, v240, s65
    v_mov_b32 v240, v52
    v_perm_b32 v52, v245, v241, s64
    v_perm_b32 v245, v245, v241, s65
    v_mov_b32 v241, v52
    v_perm_b32 v52, v246, v242, s64
    v_perm_b32 v246, v246, v242, s65
    v_mov_b32 v242, v52
    v_perm_b32 v52, v247, v243, s64
    v_perm_b32 v247, v247, v243, s65
    v_mov_b32 v243, v52
    v_mul_u32_u24 v6, 2560, v5
    s_lshl_b32 s71, s70, 2
    v_add_u32 v6, s71, v6
    v_lshl_add_u32 v57, v10, 3, v6
    v_add_u32 v57, 131072, v57
    v_lshl_add_u32 v58, v11, 3, v6
    v_add_u32 v58, 131072, v58
    v_lshl_add_u32 v59, v12, 3, v6
    v_add_u32 v59, 131072, v59
    v_lshlrev_b32 v30, 16, v26
    v_and_b32 v31, 0xffff0000, v26
    ds_write_b64 v57, v[30:31] offset:0
    v_lshlrev_b32 v30, 16, v27
    v_and_b32 v31, 0xffff0000, v27
    ds_write_b64 v58, v[30:31] offset:0
    v_lshlrev_b32 v30, 16, v28
    v_and_b32 v31, 0xffff0000, v28
    ds_write_b64 v59, v[30:31] offset:0
    s_lshl_b32 s71, s70, 3
    s_add_u32 s71, s71, 75776
    v_lshl_add_u32 v53, v10, 4, s71
    v_lshl_add_u32 v54, v11, 4, s71
    v_lshl_add_u32 v55, v12, 4, s71
    s_mov_b64 s[34:35], exec
    s_mov_b32 s33, 0x8000
Lpoll_26:
    buffer_load_dwordx4 v[16:19], v53, s[60:63], 0 offen sc1
    buffer_load_dwordx4 v[20:23], v54, s[60:63], 0 offen sc1
    buffer_load_dwordx4 v[24:27], v55, s[60:63], 0 offen sc1
    s_waitcnt vmcnt(0)
    v_cmp_ne_u32 s[38:39], s32, v17
    v_cmp_ne_u32 vcc, s32, v19
    s_or_b64 s[38:39], s[38:39], vcc
    v_cmp_ne_u32 vcc, s32, v21
    s_or_b64 s[38:39], s[38:39], vcc
    v_cmp_ne_u32 vcc, s32, v23
    s_or_b64 s[38:39], s[38:39], vcc
    v_cmp_ne_u32 vcc, s32, v25
    s_or_b64 s[38:39], s[38:39], vcc
    v_cmp_ne_u32 vcc, s32, v27
    s_or_b64 s[38:39], s[38:39], vcc
    s_and_b64 exec, exec, s[38:39]
    s_cbranch_execz Lpolld_27
    s_sub_u32 s33, s33, 1
    s_cmp_eq_u32 s33, 0
    s_cbranch_scc0 Lpoll_26
Lpolld_27:
    s_mov_b64 exec, s[34:35]
    v_lshlrev_b32 v30, v8, v16
    v_and_b32 v30, 0xffff0000, v30
    v_lshlrev_b32 v31, v8, v18
    v_and_b32 v31, 0xffff0000, v31
    ds_write_b64 v57, v[30:31] offset:5120
    v_lshlrev_b32 v30, v8, v20
    v_and_b32 v30, 0xffff0000, v30
    v_lshlrev_b32 v31, v8, v22
    v_and_b32 v31, 0xffff0000, v31
    ds_write_b64 v58, v[30:31] offset:5120
    v_lshlrev_b32 v30, v8, v24
    v_and_b32 v30, 0xffff0000, v30
    v_lshlrev_b32 v31, v8, v26
    v_and_b32 v31, 0xffff0000, v31
    ds_write_b64 v59, v[30:31] offset:5120
    s_lshl_b32 s71, s70, 3
    s_add_u32 s71, s71, 80896
    v_lshl_add_u32 v53, v10, 4, s71
    v_lshl_add_u32 v54, v11, 4, s71
    v_lshl_add_u32 v55, v12, 4, s71
    s_mov_b64 s[34:35], exec
    s_mov_b32 s33, 0x8000
Lpoll_28:
    buffer_load_dwordx4 v[16:19], v53, s[60:63], 0 offen sc1
    buffer_load_dwordx4 v[20:23], v54, s[60:63], 0 offen sc1
    buffer_load_dwordx4 v[24:27], v55, s[60:63], 0 offen sc1
    s_waitcnt vmcnt(0)
    v_cmp_ne_u32 s[38:39], s32, v17
    v_cmp_ne_u32 vcc, s32, v19
    s_or_b64 s[38:39], s[38:39], vcc
    v_cmp_ne_u32 vcc, s32, v21
    s_or_b64 s[38:39], s[38:39], vcc
    v_cmp_ne_u32 vcc, s32, v23
    s_or_b64 s[38:39], s[38:39], vcc
    v_cmp_ne_u32 vcc, s32, v25
    s_or_b64 s[38:39], s[38:39], vcc
    v_cmp_ne_u32 vcc, s32, v27
    s_or_b64 s[38:39], s[38:39], vcc
    s_and_b64 exec, exec, s[38:39]
    s_cbranch_execz Lpolld_29
    s_sub_u32 s33, s33, 1
    s_cmp_eq_u32 s33, 0
    s_cbranch_scc0 Lpoll_28
Lpolld_29:
    s_mov_b64 exec, s[34:35]
    v_lshlrev_b32 v30, v8, v16
    v_and_b32 v30, 0xffff0000, v30
    v_lshlrev_b32 v31, v8, v18
    v_and_b32 v31, 0xffff0000, v31
    ds_write_b64 v57, v[30:31] offset:15360
    v_lshlrev_b32 v30, v8, v20
    v_and_b32 v30, 0xffff0000, v30
    v_lshlrev_b32 v31, v8, v22
    v_and_b32 v31, 0xffff0000, v31
    ds_write_b64 v58, v[30:31] offset:15360
    v_lshlrev_b32 v30, v8, v24
    v_and_b32 v30, 0xffff0000, v30
    v_lshlrev_b32 v31, v8, v26
    v_and_b32 v31, 0xffff0000, v31
    ds_write_b64 v59, v[30:31] offset:15360
    s_lshl_b32 s71, s70, 3
    s_add_u32 s71, s71, 86016
    v_lshl_add_u32 v53, v10, 4, s71
    v_lshl_add_u32 v54, v11, 4, s71
    v_lshl_add_u32 v55, v12, 4, s71
    s_mov_b64 s[34:35], exec
    s_mov_b32 s33, 0x8000
Lpoll_30:
    buffer_load_dwordx4 v[16:19], v53, s[60:63], 0 offen sc1
    buffer_load_dwordx4 v[20:23], v54, s[60:63], 0 offen sc1
    buffer_load_dwordx4 v[24:27], v55, s[60:63], 0 offen sc1
    s_waitcnt vmcnt(0)
    v_cmp_ne_u32 s[38:39], s32, v17
    v_cmp_ne_u32 vcc, s32, v19
    s_or_b64 s[38:39], s[38:39], vcc
    v_cmp_ne_u32 vcc, s32, v21
    s_or_b64 s[38:39], s[38:39], vcc
    v_cmp_ne_u32 vcc, s32, v23
    s_or_b64 s[38:39], s[38:39], vcc
    v_cmp_ne_u32 vcc, s32, v25
    s_or_b64 s[38:39], s[38:39], vcc
    v_cmp_ne_u32 vcc, s32, v27
    s_or_b64 s[38:39], s[38:39], vcc
    s_and_b64 exec, exec, s[38:39]
    s_cbranch_execz Lpolld_31
    s_sub_u32 s33, s33, 1
    s_cmp_eq_u32 s33, 0
    s_cbranch_scc0 Lpoll_30
Lpolld_31:
    s_mov_b64 exec, s[34:35]
    v_lshlrev_b32 v30, v8, v16
    v_and_b32 v30, 0xffff0000, v30
    v_lshlrev_b32 v31, v8, v18
    v_and_b32 v31, 0xffff0000, v31
    v_add_f32 v30, 1.0, v30
    v_add_f32 v31, 1.0, v31
    v_cvt_pk_bf16_f32 v30, v30, v30
    v_lshlrev_b32 v30, 16, v30
    v_cvt_pk_bf16_f32 v31, v31, v31
    v_lshlrev_b32 v31, 16, v31
    ds_write_b64 v57, v[30:31] offset:10240
    v_lshlrev_b32 v30, v8, v20
    v_and_b32 v30, 0xffff0000, v30
    v_lshlrev_b32 v31, v8, v22
    v_and_b32 v31, 0xffff0000, v31
    v_add_f32 v30, 1.0, v30
    v_add_f32 v31, 1.0, v31
    v_cvt_pk_bf16_f32 v30, v30, v30
    v_lshlrev_b32 v30, 16, v30
    v_cvt_pk_bf16_f32 v31, v31, v31
    v_lshlrev_b32 v31, 16, v31
    ds_write_b64 v58, v[30:31] offset:10240
    v_lshlrev_b32 v30, v8, v24
    v_and_b32 v30, 0xffff0000, v30
    v_lshlrev_b32 v31, v8, v26
    v_and_b32 v31, 0xffff0000, v31
    v_add_f32 v30, 1.0, v30
    v_add_f32 v31, 1.0, v31
    v_cvt_pk_bf16_f32 v30, v30, v30
    v_lshlrev_b32 v30, 16, v30
    v_cvt_pk_bf16_f32 v31, v31, v31
    v_lshlrev_b32 v31, 16, v31
    ds_write_b64 v59, v[30:31] offset:10240
    s_waitcnt lgkmcnt(0)
    s_branch Lpre_done
Lpre_z:
    s_cmp_eq_u32 s68, 3
    s_cbranch_scc0 Lpre_done
    s_sub_u32 s72, s14, 134
    s_cmp_ge_u32 s72, 20
    s_cselect_b32 s73, 1, 0
    s_mul_i32 s74, s73, 20
    s_sub_u32 s72, s72, s74
    s_mov_b32 s56, s4
    s_and_b32 s57, s5, 0xffff
    s_mov_b32 s58, 2560
    s_mov_b32 s59, 0x20000
    v_and_b32 v6, 7, v1
    s_mul_i32 s71, s73, 1280
    s_lshl_b32 s74, s72, 6
    s_add_u32 s71, s71, s74
    v_lshl_add_u32 v7, v6, 3, s71
    buffer_load_dwordx2 v[26:27], v7, s[56:59], 0 offen
    s_lshl_b32 s71, s72, 8
    s_add_u32 s71, s71, 75776
    v_lshl_add_u32 v7, v6, 5, s71
    s_mov_b64 s[34:35], exec
    s_mov_b32 s33, 0x8000
Lpoll_32:
    buffer_load_dwordx4 v[16:19], v7, s[60:63], 0 offen sc1
    buffer_load_dwordx4 v[20:23], v7, s[60:63], 0 offen offset:16 sc1
    s_movk_i32 s36, 15360
    buffer_load_dwordx4 v[30:33], v7, s[60:63], s36 offen sc1
    buffer_load_dwordx4 v[34:37], v7, s[60:63], s36 offen offset:16 sc1
    s_waitcnt vmcnt(0)
    v_cmp_ne_u32 s[38:39], s32, v17
    v_cmp_ne_u32 vcc, s32, v19
    s_or_b64 s[38:39], s[38:39], vcc
    v_cmp_ne_u32 vcc, s32, v21
    s_or_b64 s[38:39], s[38:39], vcc
    v_cmp_ne_u32 vcc, s32, v23
    s_or_b64 s[38:39], s[38:39], vcc
    v_cmp_ne_u32 vcc, s32, v31
    s_or_b64 s[38:39], s[38:39], vcc
    v_cmp_ne_u32 vcc, s32, v33
    s_or_b64 s[38:39], s[38:39], vcc
    v_cmp_ne_u32 vcc, s32, v35
    s_or_b64 s[38:39], s[38:39], vcc
    v_cmp_ne_u32 vcc, s32, v37
    s_or_b64 s[38:39], s[38:39], vcc
    s_and_b64 exec, exec, s[38:39]
    s_cbranch_execz Lpolld_33
    s_sub_u32 s33, s33, 1
    s_cmp_eq_u32 s33, 0
    s_cbranch_scc0 Lpoll_32
Lpolld_33:
    s_mov_b64 exec, s[34:35]
    s_lshl_b32 s74, s73, 4
    s_sub_u32 s74, 16, s74
    v_mov_b32 v8, s74
    v_lshlrev_b32 v128, v8, v16
    v_and_b32 v128, 0xffff0000, v128
    v_lshlrev_b32 v132, v8, v30
    v_and_b32 v132, 0xffff0000, v132
    v_lshlrev_b32 v129, v8, v18
    v_and_b32 v129, 0xffff0000, v129
    v_lshlrev_b32 v133, v8, v32
    v_and_b32 v133, 0xffff0000, v133
    v_lshlrev_b32 v130, v8, v20
    v_and_b32 v130, 0xffff0000, v130
    v_lshlrev_b32 v134, v8, v34
    v_and_b32 v134, 0xffff0000, v134
    v_lshlrev_b32 v131, v8, v22
    v_and_b32 v131, 0xffff0000, v131
    v_lshlrev_b32 v135, v8, v36
    v_and_b32 v135, 0xffff0000, v135
    v_lshlrev_b32 v136, 16, v26
    v_and_b32 v137, 0xffff0000, v26
    v_lshlrev_b32 v138, 16, v27
    v_and_b32 v139, 0xffff0000, v27
Lpre_done:
    s_barrier
    s_lshr_b32 s71, s68, 1
    s_mul_i32 s74, s71, 2112
    s_add_u32 s74, s74, 151552
    s_and_b32 s75, s68, 1
    s_lshl_b32 s75, s75, 8
    v_mov_b32 v6, s74
    v_lshl_add_u32 v7, v1, 2, s75
    v_add_u32 v7, s74, v7
    ds_read_b64 v[16:17], v6 offset:512
    ds_read_b32 v24, v7 offset:0
    ds_read_b64 v[18:19], v6 offset:1040
    ds_read_b32 v25, v7 offset:528
    ds_read_b64 v[20:21], v6 offset:1568
    ds_read_b32 v26, v7 offset:1056
    ds_read_b64 v[22:23], v6 offset:2096
    ds_read_b32 v27, v7 offset:1584
    s_mov_b32 s36, 0x3e0293ee
    s_waitcnt lgkmcnt(0)
    v_max3_f32 v28, v16, v18, v20
    v_max_f32 v28, v28, v22
    v_sub_f32 v16, v16, v28
    v_mul_f32 v16, s36, v16
    v_exp_f32 v16, v16
    v_sub_f32 v18, v18, v28
    v_mul_f32 v18, s36, v18
    v_exp_f32 v18, v18
    v_sub_f32 v20, v20, v28
    v_mul_f32 v20, s36, v20
    v_exp_f32 v20, v20
    v_sub_f32 v22, v22, v28
    v_mul_f32 v22, s36, v22
    v_exp_f32 v22, v22
    s_nop 0
    v_mul_f32 v30, v16, v24
    v_mul_f32 v29, v16, v17
    v_fmac_f32 v30, v18, v25
    v_fmac_f32 v29, v18, v19
    v_fmac_f32 v30, v20, v26
    v_fmac_f32 v29, v20, v21
    v_fmac_f32 v30, v22, v27
    v_fmac_f32 v29, v22, v23
    s_lshr_b32 s72, s2, 3
    s_lshl_b32 s72, s72, 1
    s_add_u32 s72, s72, s71
    s_lshl_b32 s72, s72, 3
    s_and_b32 s73, s2, 7
    s_add_u32 s72, s72, s73
    s_mul_i32 s72, s72, 528
    s_add_u32 s72, s72, 196608
    s_add_u32 s73, s72, s75
    v_lshl_add_u32 v7, v1, 2, s73
    buffer_store_dword v30, v7, s[60:63], 0 offen sc1
    s_cmp_eq_u32 s75, 0
    s_cbranch_scc0 Lt0_done
    v_mov_b32 v7, s72
    s_mov_b64 exec, 1
    buffer_store_dwordx2 v[28:29], v7, s[60:63], 0 offen offset:512 sc1
    s_mov_b64 exec, -1
Lt0_done:
    s_cmp_lt_u32 s14, 80
    s_cbranch_scc1 Lrole_o
    s_cmp_lt_u32 s14, 134
    s_cbranch_scc1 Lrole_f
    s_cmp_lt_u32 s14, 174
    s_cbranch_scc1 Lrole_z
    s_branch Lhelp_end
Lrole_o:
    s_mul_i32 s72, s14, 205
    s_lshr_b32 s72, s72, 11
    s_mul_i32 s73, s72, 10
    s_sub_u32 s73, s14, s73
    s_lshl_b32 s71, s72, 2
    s_add_u32 s71, s71, s68
    s_mul_i32 s71, s71, 8448
    s_add_u32 s71, s71, 196608
    v_mul_u32_u24 v6, 4224, v5
    v_add_u32 v6, s71, v6
    v_lshl_add_u32 v7, v4, 4, v6
    s_mov_b64 s[34:35], exec
    s_mov_b32 s33, 0x8000
Lpoll_34:
    s_movk_i32 s36, 0
    buffer_load_dwordx4 v[16:19], v7, s[60:63], s36 offen sc1
    buffer_load_dwordx2 v[48:49], v6, s[60:63], s36 offen offset:512 sc1
    s_movk_i32 s36, 528
    buffer_load_dwordx4 v[20:23], v7, s[60:63], s36 offen sc1
    buffer_load_dwordx2 v[50:51], v6, s[60:63], s36 offen offset:512 sc1
    s_movk_i32 s36, 1056
    buffer_load_dwordx4 v[24:27], v7, s[60:63], s36 offen sc1
    buffer_load_dwordx2 v[52:53], v6, s[60:63], s36 offen offset:512 sc1
    s_movk_i32 s36, 1584
    buffer_load_dwordx4 v[28:31], v7, s[60:63], s36 offen sc1
    buffer_load_dwordx2 v[54:55], v6, s[60:63], s36 offen offset:512 sc1
    s_movk_i32 s36, 2112
    buffer_load_dwordx4 v[32:35], v7, s[60:63], s36 offen sc1
    buffer_load_dwordx2 v[56:57], v6, s[60:63], s36 offen offset:512 sc1
    s_movk_i32 s36, 2640
    buffer_load_dwordx4 v[36:39], v7, s[60:63], s36 offen sc1
    buffer_load_dwordx2 v[58:59], v6, s[60:63], s36 offen offset:512 sc1
    s_movk_i32 s36, 3168
    buffer_load_dwordx4 v[40:43], v7, s[60:63], s36 offen sc1
    buffer_load_dwordx2 v[60:61], v6, s[60:63], s36 offen offset:512 sc1
    s_movk_i32 s36, 3696
    buffer_load_dwordx4 v[44:47], v7, s[60:63], s36 offen sc1
    buffer_load_dwordx2 v[62:63], v6, s[60:63], s36 offen offset:512 sc1
    s_waitcnt vmcnt(0)
    v_max3_u32 v64, v16, v17, v18
    v_max3_u32 v64, v64, v19, v20
    v_max3_u32 v64, v64, v21, v22
    v_max3_u32 v64, v64, v23, v24
    v_max3_u32 v64, v64, v25, v26
    v_max3_u32 v64, v64, v27, v28
    v_max3_u32 v64, v64, v29, v30
    v_max3_u32 v64, v64, v31, v32
    v_max3_u32 v64, v64, v33, v34
    v_max3_u32 v64, v64, v35, v36
    v_max3_u32 v64, v64, v37, v38
    v_max3_u32 v64, v64, v39, v40
    v_max3_u32 v64, v64, v41, v42
    v_max3_u32 v64, v64, v43, v44
    v_max3_u32 v64, v64, v45, v46
    v_max3_u32 v64, v64, v47, v48
    v_max3_u32 v64, v64, v49, v50
    v_max3_u32 v64, v64, v51, v52
    v_max3_u32 v64, v64, v53, v54
    v_max3_u32 v64, v64, v55, v56
    v_max3_u32 v64, v64, v57, v58
    v_max3_u32 v64, v64, v59, v60
    v_max3_u32 v64, v64, v61, v62
    v_max3_u32 v64, v64, v63, v63
    v_cmp_eq_u32 s[38:39], -1, v64
    s_and_b64 exec, exec, s[38:39]
    s_cbranch_execz Lpolld_35
    s_sub_u32 s33, s33, 1
    s_cmp_eq_u32 s33, 0
    s_cbranch_scc0 Lpoll_34
Lpolld_35:
    s_mov_b64 exec, s[34:35]
    v_max3_f32 v64, v48, v50, v52
    v_max3_f32 v64, v64, v54, v56
    v_max3_f32 v64, v64, v58, v60
    v_max_f32 v64, v64, v62
    s_mov_b32 s36, 0x3e0293ee
    v_sub_f32 v48, v48, v64
    v_mul_f32 v48, s36, v48
    v_exp_f32 v48, v48
    v_sub_f32 v50, v50, v64
    v_mul_f32 v50, s36, v50
    v_exp_f32 v50, v50
    v_sub_f32 v52, v52, v64
    v_mul_f32 v52, s36, v52
    v_exp_f32 v52, v52
    v_sub_f32 v54, v54, v64
    v_mul_f32 v54, s36, v54
    v_exp_f32 v54, v54
    v_sub_f32 v56, v56, v64
    v_mul_f32 v56, s36, v56
    v_exp_f32 v56, v56
    v_sub_f32 v58, v58, v64
    v_mul_f32 v58, s36, v58
    v_exp_f32 v58, v58
    v_sub_f32 v60, v60, v64
    v_mul_f32 v60, s36, v60
    v_exp_f32 v60, v60
    v_sub_f32 v62, v62, v64
    v_mul_f32 v62, s36, v62
    v_exp_f32 v62, v62
    s_nop 0
    v_mul_f32 v65, v48, v49
    v_fmac_f32 v65, v50, v51
    v_fmac_f32 v65, v52, v53
    v_fmac_f32 v65, v54, v55
    v_fmac_f32 v65, v56, v57
    v_fmac_f32 v65, v58, v59
    v_fmac_f32 v65, v60, v61
    v_fmac_f32 v65, v62, v63
    v_rcp_f32 v65, v65
    v_mul_f32 v66, v48, v16
    v_mul_f32 v67, v48, v17
    v_mul_f32 v68, v48, v18
    v_mul_f32 v69, v48, v19
    v_fmac_f32 v66, v50, v20
    v_fmac_f32 v67, v50, v21
    v_fmac_f32 v68, v50, v22
    v_fmac_f32 v69, v50, v23
    v_fmac_f32 v66, v52, v24
    v_fmac_f32 v67, v52, v25
    v_fmac_f32 v68, v52, v26
    v_fmac_f32 v69, v52, v27
    v_fmac_f32 v66, v54, v28
    v_fmac_f32 v67, v54, v29
    v_fmac_f32 v68, v54, v30
    v_fmac_f32 v69, v54, v31
    v_fmac_f32 v66, v56, v32
    v_fmac_f32 v67, v56, v33
    v_fmac_f32 v68, v56, v34
    v_fmac_f32 v69, v56, v35
    v_fmac_f32 v66, v58, v36
    v_fmac_f32 v67, v58, v37
    v_fmac_f32 v68, v58, v38
    v_fmac_f32 v69, v58, v39
    v_fmac_f32 v66, v60, v40
    v_fmac_f32 v67, v60, v41
    v_fmac_f32 v68, v60, v42
    v_fmac_f32 v69, v60, v43
    v_fmac_f32 v66, v62, v44
    v_fmac_f32 v67, v62, v45
    v_fmac_f32 v68, v62, v46
    v_fmac_f32 v69, v62, v47
    v_mul_f32 v66, v66, v65
    v_mul_f32 v67, v67, v65
    v_mul_f32 v68, v68, v65
    v_mul_f32 v69, v69, v65
    v_cvt_pk_bf16_f32 v66, v66, v67
    v_cvt_pk_bf16_f32 v67, v68, v69
    s_lshl_b32 s74, s68, 9
    s_add_u32 s74, s74, 155776
    v_lshlrev_b32 v6, 8, v5
    v_lshl_add_u32 v6, v4, 3, v6
    v_add_u32 v6, s74, v6
    ds_write_b64 v6, v[66:67]
    v_and_b32 v6, 1, v2
    v_lshlrev_b32 v6, 8, v6
    v_lshl_add_u32 v6, v3, 4, v6
    v_add_u32 v6, s74, v6
    s_waitcnt lgkmcnt(0)
    ds_read_b128 v[16:19], v6 offset:0
    ds_read_b128 v[20:23], v6 offset:64
    ds_read_b128 v[24:27], v6 offset:128
    ds_read_b128 v[28:31], v6 offset:192
    s_waitcnt lgkmcnt(0)
    v_mfma_f32_16x16x32_bf16 v[32:35], v[16:19], v[128:131], 0
    v_mfma_f32_16x16x32_bf16 v[36:39], v[16:19], v[132:135], 0
    v_mfma_f32_16x16x32_bf16 v[32:35], v[20:23], v[136:139], v[32:35]
    v_mfma_f32_16x16x32_bf16 v[36:39], v[20:23], v[140:143], v[36:39]
    v_mfma_f32_16x16x32_bf16 v[32:35], v[24:27], v[144:147], v[32:35]
    v_mfma_f32_16x16x32_bf16 v[36:39], v[24:27], v[148:151], v[36:39]
    v_mfma_f32_16x16x32_bf16 v[32:35], v[28:31], v[152:155], v[32:35]
    v_mfma_f32_16x16x32_bf16 v[36:39], v[28:31], v[156:159], v[36:39]
    v_mfma_f32_16x16x32_bf16 v[40:43], v[16:19], v[160:163], 0
    v_mfma_f32_16x16x32_bf16 v[44:47], v[16:19], v[164:167], 0
    v_mfma_f32_16x16x32_bf16 v[40:43], v[20:23], v[168:171], v[40:43]
    v_mfma_f32_16x16x32_bf16 v[44:47], v[20:23], v[172:175], v[44:47]
    v_mfma_f32_16x16x32_bf16 v[40:43], v[24:27], v[176:179], v[40:43]
    v_mfma_f32_16x16x32_bf16 v[44:47], v[24:27], v[180:183], v[44:47]
    v_mfma_f32_16x16x32_bf16 v[40:43], v[28:31], v[184:187], v[40:43]
    v_mfma_f32_16x16x32_bf16 v[44:47], v[28:31], v[188:191], v[44:47]
    s_lshl_b32 s74, s68, 9
    s_add_u32 s74, s74, 158336
    v_lshl_add_u32 v6, v2, 4, s74
    s_nop 7
    s_mov_b64 exec, 0xffff
    ds_write2_b32 v6, v32, v36 offset0:0 offset1:1
    ds_write2_b32 v6, v33, v37 offset0:64 offset1:65
    ds_write2_b32 v6, v40, v44 offset0:2 offset1:3
    ds_write2_b32 v6, v41, v45 offset0:66 offset1:67
    s_mov_b64 exec, -1
    s_waitcnt lgkmcnt(0)
    s_barrier
    s_cmp_eq_u32 s68, 0
    s_cbranch_scc0 Lhelp_end
    v_lshlrev_b32 v6, 3, v1
    v_add_u32 v6, 158336, v6
    ds_read_b64 v[16:17], v6 offset:0
    ds_read_b64 v[18:19], v6 offset:512
    ds_read_b64 v[20:21], v6 offset:1024
    ds_read_b64 v[22:23], v6 offset:1536
    s_mul_i32 s71, s72, 5120
    s_lshl_b32 s74, s73, 8
    s_add_u32 s71, s71, s74
    s_add_u32 s71, s71, 524288
    v_mul_u32_u24 v6, 2560, v5
    v_lshl_add_u32 v6, v4, 3, v6
    v_add_u32 v6, s71, v6
    s_waitcnt lgkmcnt(0)
    v_add_f32 v16, v16, v18
    v_add_f32 v17, v17, v19
    v_add_f32 v20, v20, v22
    v_add_f32 v21, v21, v23
    v_add_f32 v16, v16, v20
    v_add_f32 v17, v17, v21
    buffer_store_dwordx2 v[16:17], v6, s[60:63], 0 offen sc1
    s_branch Lhelp_end
Lrole_f:
    s_cmp_eq_u32 s68, 0
    s_cbranch_scc1 Lffn_x
    s_barrier
    s_barrier
    s_branch Lffn_mma
Lffn_x:
    v_and_b32 v4, 31, v1
    v_lshrrev_b32 v5, 5, v1
    v_mul_u32_u24 v6, 2560, v5
    v_lshl_add_u32 v6, v4, 4, v6
    s_lshl_b32 s71, s3, 9
    v_add_u32 v6, s71, v6
    v_add_u32 v7, 524288, v6
    v_add_u32 v6, 131072, v6
    ds_read_b128 v[48:51], v6 offset:0
    ds_read_b128 v[52:55], v6 offset:5120
    ds_read_b128 v[56:59], v6 offset:10240
    ds_read_b128 v[60:63], v6 offset:15360
    s_mov_b64 s[34:35], exec
    s_mov_b32 s33, 0x8000
Lpoll_36:
    s_mov_b32 s36, 0
    buffer_load_dwordx4 v[16:19], v7, s[60:63], s36 offen sc1
    s_mov_b32 s36, 5120
    buffer_load_dwordx4 v[20:23], v7, s[60:63], s36 offen sc1
    s_mov_b32 s36, 10240
    buffer_load_dwordx4 v[24:27], v7, s[60:63], s36 offen sc1
    s_mov_b32 s36, 15360
    buffer_load_dwordx4 v[28:31], v7, s[60:63], s36 offen sc1
    s_mov_b32 s36, 20480
    buffer_load_dwordx4 v[32:35], v7, s[60:63], s36 offen sc1
    s_mov_b32 s36, 25600
    buffer_load_dwordx4 v[36:39], v7, s[60:63], s36 offen sc1
    s_mov_b32 s36, 30720
    buffer_load_dwordx4 v[40:43], v7, s[60:63], s36 offen sc1
    s_mov_b32 s36, 35840
    buffer_load_dwordx4 v[44:47], v7, s[60:63], s36 offen sc1
    s_waitcnt vmcnt(0)
    v_max3_u32 v64, v16, v17, v18
    v_max3_u32 v64, v64, v19, v20
    v_max3_u32 v64, v64, v21, v22
    v_max3_u32 v64, v64, v23, v24
    v_max3_u32 v64, v64, v25, v26
    v_max3_u32 v64, v64, v27, v28
    v_max3_u32 v64, v64, v29, v30
    v_max3_u32 v64, v64, v31, v32
    v_max3_u32 v64, v64, v33, v34
    v_max3_u32 v64, v64, v35, v36
    v_max3_u32 v64, v64, v37, v38
    v_max3_u32 v64, v64, v39, v40
    v_max3_u32 v64, v64, v41, v42
    v_max3_u32 v64, v64, v43, v44
    v_max3_u32 v64, v64, v45, v46
    v_max3_u32 v64, v64, v47, v47
    v_cmp_eq_u32 s[38:39], -1, v64
    s_and_b64 exec, exec, s[38:39]
    s_cbranch_execz Lpolld_37
    s_sub_u32 s33, s33, 1
    s_cmp_eq_u32 s33, 0
    s_cbranch_scc0 Lpoll_36
Lpolld_37:
    s_mov_b64 exec, s[34:35]
    s_waitcnt lgkmcnt(0)
    v_add_f32 v16, v16, v20
    v_add_f32 v24, v24, v28
    v_add_f32 v32, v32, v36
    v_add_f32 v40, v40, v44
    v_add_f32 v16, v16, v24
    v_add_f32 v32, v32, v40
    v_add_f32 v16, v16, v32
    v_cvt_pk_bf16_f32 v16, v16, v16
    v_lshlrev_b32 v16, 16, v16
    v_mul_f32 v16, v16, v52
    v_cvt_pk_bf16_f32 v16, v16, v16
    v_lshlrev_b32 v16, 16, v16
    v_add_f32 v16, v16, v48
    v_cvt_pk_bf16_f32 v16, v16, v16
    v_lshlrev_b32 v16, 16, v16
    v_add_f32 v17, v17, v21
    v_add_f32 v25, v25, v29
    v_add_f32 v33, v33, v37
    v_add_f32 v41, v41, v45
    v_add_f32 v17, v17, v25
    v_add_f32 v33, v33, v41
    v_add_f32 v17, v17, v33
    v_cvt_pk_bf16_f32 v17, v17, v17
    v_lshlrev_b32 v17, 16, v17
    v_mul_f32 v17, v17, v53
    v_cvt_pk_bf16_f32 v17, v17, v17
    v_lshlrev_b32 v17, 16, v17
    v_add_f32 v17, v17, v49
    v_cvt_pk_bf16_f32 v17, v17, v17
    v_lshlrev_b32 v17, 16, v17
    v_add_f32 v18, v18, v22
    v_add_f32 v26, v26, v30
    v_add_f32 v34, v34, v38
    v_add_f32 v42, v42, v46
    v_add_f32 v18, v18, v26
    v_add_f32 v34, v34, v42
    v_add_f32 v18, v18, v34
    v_cvt_pk_bf16_f32 v18, v18, v18
    v_lshlrev_b32 v18, 16, v18
    v_mul_f32 v18, v18, v54
    v_cvt_pk_bf16_f32 v18, v18, v18
    v_lshlrev_b32 v18, 16, v18
    v_add_f32 v18, v18, v50
    v_cvt_pk_bf16_f32 v18, v18, v18
    v_lshlrev_b32 v18, 16, v18
    v_add_f32 v19, v19, v23
    v_add_f32 v27, v27, v31
    v_add_f32 v35, v35, v39
    v_add_f32 v43, v43, v47
    v_add_f32 v19, v19, v27
    v_add_f32 v35, v35, v43
    v_add_f32 v19, v19, v35
    v_cvt_pk_bf16_f32 v19, v19, v19
    v_lshlrev_b32 v19, 16, v19
    v_mul_f32 v19, v19, v55
    v_cvt_pk_bf16_f32 v19, v19, v19
    v_lshlrev_b32 v19, 16, v19
    v_add_f32 v19, v19, v51
    v_cvt_pk_bf16_f32 v19, v19, v19
    v_lshlrev_b32 v19, 16, v19
    v_add_f32 v20, v16, v17
    v_add_f32 v20, v20, v18
    v_add_f32 v20, v20, v19
    s_nop 1
    v_add_f32_dpp v20, v20, v20 row_ror:8 row_mask:0xf bank_mask:0xf
    s_nop 1
    v_add_f32_dpp v20, v20, v20 row_ror:4 row_mask:0xf bank_mask:0xf
    s_nop 1
    v_add_f32_dpp v20, v20, v20 row_ror:2 row_mask:0xf bank_mask:0xf
    s_nop 1
    v_add_f32_dpp v20, v20, v20 row_ror:1 row_mask:0xf bank_mask:0xf
    v_mov_b32 v22, v20
    s_nop 1
    v_permlane16_swap_b32 v20, v22
    v_add_f32 v20, v20, v22
    v_mul_f32 v20, 0x3c000000, v20
    v_sub_f32 v22, v16, v20
    v_mul_f32 v21, v22, v22
    v_sub_f32 v22, v17, v20
    v_fmac_f32 v21, v22, v22
    v_sub_f32 v22, v18, v20
    v_fmac_f32 v21, v22, v22
    v_sub_f32 v22, v19, v20
    v_fmac_f32 v21, v22, v22
    s_nop 1
    v_add_f32_dpp v21, v21, v21 row_ror:8 row_mask:0xf bank_mask:0xf
    s_nop 1
    v_add_f32_dpp v21, v21, v21 row_ror:4 row_mask:0xf bank_mask:0xf
    s_nop 1
    v_add_f32_dpp v21, v21, v21 row_ror:2 row_mask:0xf bank_mask:0xf
    s_nop 1
    v_add_f32_dpp v21, v21, v21 row_ror:1 row_mask:0xf bank_mask:0xf
    v_mov_b32 v22, v21
    s_nop 1
    v_permlane16_swap_b32 v21, v22
    v_add_f32 v21, v21, v22
    s_lshl_b32 s71, s3, 4
    s_add_u32 s71, s71, 160896
    v_lshl_add_u32 v7, v5, 3, s71
    ds_write_b64 v7, v[20:21]
    s_waitcnt lgkmcnt(0)
    s_barrier
    v_lshlrev_b32 v7, 3, v5
    v_add_u32 v7, 160896, v7
    ds_read_b64 v[24:25], v7 offset:0
    ds_read_b64 v[26:27], v7 offset:16
    ds_read_b64 v[28:29], v7 offset:32
    ds_read_b64 v[30:31], v7 offset:48
    ds_read_b64 v[32:33], v7 offset:64
    s_waitcnt lgkmcnt(0)
    v_add_f32 v20, v24, v26
    v_add_f32 v21, v28, v30
    v_add_f32 v20, v20, v32
    v_add_f32 v20, v20, v21
    v_mul_f32 v20, 0x3e4ccccd, v20
    v_add_f32 v21, v25, v27
    v_add_f32 v22, v29, v31
    v_add_f32 v21, v21, v33
    v_add_f32 v21, v21, v22
    v_mov_b32 v23, 0
    v_sub_f32 v22, v24, v20
    v_fmac_f32 v23, v22, v22
    v_sub_f32 v22, v26, v20
    v_fmac_f32 v23, v22, v22
    v_sub_f32 v22, v28, v20
    v_fmac_f32 v23, v22, v22
    v_sub_f32 v22, v30, v20
    v_fmac_f32 v23, v22, v22
    v_sub_f32 v22, v32, v20
    v_fmac_f32 v23, v22, v22
    v_fmac_f32 v21, 0x43000000, v23
    v_mul_f32 v21, 0x3acccccd, v21
    v_cvt_pk_bf16_f32 v21, v21, v21
    v_lshlrev_b32 v21, 16, v21
    v_add_f32 v21, 0x3727c5ac, v21
    v_cvt_pk_bf16_f32 v21, v21, v21
    v_lshlrev_b32 v21, 16, v21
    v_sqrt_f32 v21, v21
    s_nop 0
    v_cvt_pk_bf16_f32 v21, v21, v21
    v_lshlrev_b32 v21, 16, v21
    v_rcp_f32 v21, v21
    v_cvt_pk_bf16_f32 v20, v20, v20
    v_lshlrev_b32 v20, 16, v20
    s_nop 0
    v_sub_f32 v16, v16, v20
    v_cvt_pk_bf16_f32 v16, v16, v16
    v_lshlrev_b32 v16, 16, v16
    v_mul_f32 v16, v16, v21
    v_cvt_pk_bf16_f32 v16, v16, v16
    v_lshlrev_b32 v16, 16, v16
    v_mul_f32 v16, v16, v56
    v_cvt_pk_bf16_f32 v16, v16, v16
    v_lshlrev_b32 v16, 16, v16
    v_add_f32 v16, v16, v60
    v_sub_f32 v17, v17, v20
    v_cvt_pk_bf16_f32 v17, v17, v17
    v_lshlrev_b32 v17, 16, v17
    v_mul_f32 v17, v17, v21
    v_cvt_pk_bf16_f32 v17, v17, v17
    v_lshlrev_b32 v17, 16, v17
    v_mul_f32 v17, v17, v57
    v_cvt_pk_bf16_f32 v17, v17, v17
    v_lshlrev_b32 v17, 16, v17
    v_add_f32 v17, v17, v61
    v_sub_f32 v18, v18, v20
    v_cvt_pk_bf16_f32 v18, v18, v18
    v_lshlrev_b32 v18, 16, v18
    v_mul_f32 v18, v18, v21
    v_cvt_pk_bf16_f32 v18, v18, v18
    v_lshlrev_b32 v18, 16, v18
    v_mul_f32 v18, v18, v58
    v_cvt_pk_bf16_f32 v18, v18, v18
    v_lshlrev_b32 v18, 16, v18
    v_add_f32 v18, v18, v62
    v_sub_f32 v19, v19, v20
    v_cvt_pk_bf16_f32 v19, v19, v19
    v_lshlrev_b32 v19, 16, v19
    v_mul_f32 v19, v19, v21
    v_cvt_pk_bf16_f32 v19, v19, v19
    v_lshlrev_b32 v19, 16, v19
    v_mul_f32 v19, v19, v59
    v_cvt_pk_bf16_f32 v19, v19, v19
    v_lshlrev_b32 v19, 16, v19
    v_add_f32 v19, v19, v63
    v_cvt_pk_bf16_f32 v16, v16, v17
    v_cvt_pk_bf16_f32 v17, v18, v19
    v_mul_u32_u24 v7, 1280, v5
    v_lshl_add_u32 v7, v4, 3, v7
    s_lshl_b32 s71, s3, 8
    s_add_u32 s71, s71, 155776
    v_add_u32 v7, s71, v7
    ds_write_b64 v7, v[16:17]
    s_waitcnt lgkmcnt(0)
    s_barrier
    s_cmp_lt_u32 s3, 4
    s_cbranch_scc1 Lend
Lffn_mma:
    s_mul_i32 s71, s68, 320
    s_add_u32 s71, s71, 155776
    v_and_b32 v6, 1, v2
    v_mul_u32_u24 v6, 1280, v6
    v_lshl_add_u32 v6, v3, 4, v6
    v_add_u32 v6, s71, v6
    ds_read_b128 v[16:19], v6 offset:0
    ds_read_b128 v[20:23], v6 offset:64
    ds_read_b128 v[24:27], v6 offset:128
    ds_read_b128 v[28:31], v6 offset:192
    ds_read_b128 v[32:35], v6 offset:256
    s_waitcnt lgkmcnt(0)
    v_mfma_f32_16x16x32_bf16 v[40:43], v[16:19], v[128:131], 0
    v_mfma_f32_16x16x32_bf16 v[44:47], v[16:19], v[132:135], 0
    v_mfma_f32_16x16x32_bf16 v[40:43], v[20:23], v[136:139], v[40:43]
    v_mfma_f32_16x16x32_bf16 v[44:47], v[20:23], v[140:143], v[44:47]
    v_mfma_f32_16x16x32_bf16 v[40:43], v[24:27], v[144:147], v[40:43]
    v_mfma_f32_16x16x32_bf16 v[44:47], v[24:27], v[148:151], v[44:47]
    v_mfma_f32_16x16x32_bf16 v[40:43], v[28:31], v[152:155], v[40:43]
    v_mfma_f32_16x16x32_bf16 v[44:47], v[28:31], v[156:159], v[44:47]
    v_mfma_f32_16x16x32_bf16 v[40:43], v[32:35], v[160:163], v[40:43]
    v_mfma_f32_16x16x32_bf16 v[44:47], v[32:35], v[164:167], v[44:47]
    v_mfma_f32_16x16x32_bf16 v[48:51], v[16:19], v[168:171], 0
    v_mfma_f32_16x16x32_bf16 v[52:55], v[16:19], v[172:175], 0
    v_mfma_f32_16x16x32_bf16 v[48:51], v[20:23], v[176:179], v[48:51]
    v_mfma_f32_16x16x32_bf16 v[52:55], v[20:23], v[180:183], v[52:55]
    v_mfma_f32_16x16x32_bf16 v[48:51], v[24:27], v[184:187], v[48:51]
    v_mfma_f32_16x16x32_bf16 v[52:55], v[24:27], v[188:191], v[52:55]
    v_mfma_f32_16x16x32_bf16 v[48:51], v[28:31], v[192:195], v[48:51]
    v_mfma_f32_16x16x32_bf16 v[52:55], v[28:31], v[196:199], v[52:55]
    v_mfma_f32_16x16x32_bf16 v[48:51], v[32:35], v[200:203], v[48:51]
    v_mfma_f32_16x16x32_bf16 v[52:55], v[32:35], v[204:207], v[52:55]
    s_lshl_b32 s74, s68, 9
    s_add_u32 s74, s74, 158336
    v_lshl_add_u32 v6, v2, 3, s74
    s_nop 7
    s_mov_b64 exec, 0xffff
    ds_write2_b32 v6, v40, v44 offset0:0 offset1:1
    ds_write2_b32 v6, v41, v45 offset0:32 offset1:33
    ds_write2_b32 v6, v48, v52 offset0:64 offset1:65
    ds_write2_b32 v6, v49, v53 offset0:96 offset1:97
    s_mov_b64 exec, -1
    s_waitcnt lgkmcnt(0)
    s_barrier
    v_lshlrev_b32 v6, 2, v1
    v_add_u32 v6, 158336, v6
    ds_read_b32 v16, v6 offset:0
    ds_read_b32 v20, v6 offset:256
    ds_read_b32 v17, v6 offset:512
    ds_read_b32 v21, v6 offset:768
    ds_read_b32 v18, v6 offset:1024
    ds_read_b32 v22, v6 offset:1280
    ds_read_b32 v19, v6 offset:1536
    ds_read_b32 v23, v6 offset:1792
    s_waitcnt lgkmcnt(0)
    v_add_f32 v16, v16, v17
    v_add_f32 v18, v18, v19
    v_add_f32 v20, v20, v21
    v_add_f32 v22, v22, v23
    v_add_f32 v16, v16, v18
    v_add_f32 v20, v20, v22
    v_cvt_pk_bf16_f32 v16, v16, v16
    v_lshlrev_b32 v16, 16, v16
    v_cvt_pk_bf16_f32 v20, v20, v20
    v_lshlrev_b32 v20, 16, v20
    v_mul_f32 v17, s37, v16
    v_exp_f32 v17, v17
    s_nop 0
    v_add_f32 v17, 1.0, v17
    v_rcp_f32 v17, v17
    s_nop 0
    v_mul_f32 v16, v16, v17
    v_cvt_pk_bf16_f32 v16, v16, v16
    v_lshlrev_b32 v16, 16, v16
    v_mul_f32 v16, v16, v20
    v_cvt_pk_bf16_f32 v16, v16, v16
    s_lshl_b32 s74, s68, 7
    s_add_u32 s74, s74, 161408
    v_lshl_add_u32 v6, v1, 1, s74
    ds_write_b16 v6, v16
    v_and_b32 v6, 1, v2
    v_lshlrev_b32 v6, 6, v6
    v_lshl_add_u32 v6, v3, 4, v6
    v_add_u32 v6, s74, v6
    s_waitcnt lgkmcnt(0)
    ds_read_b128 v[16:19], v6
    s_waitcnt lgkmcnt(0)
    v_mfma_f32_16x16x32_bf16 v[24:27], v[16:19], v[208:211], 0
    v_mfma_f32_16x16x32_bf16 v[28:31], v[16:19], v[212:215], 0
    v_mfma_f32_16x16x32_bf16 v[32:35], v[16:19], v[216:219], 0
    v_mfma_f32_16x16x32_bf16 v[36:39], v[16:19], v[220:223], 0
    v_mfma_f32_16x16x32_bf16 v[40:43], v[16:19], v[224:227], 0
    v_mfma_f32_16x16x32_bf16 v[44:47], v[16:19], v[228:231], 0
    v_mfma_f32_16x16x32_bf16 v[48:51], v[16:19], v[232:235], 0
    v_mfma_f32_16x16x32_bf16 v[52:55], v[16:19], v[236:239], 0
    v_mfma_f32_16x16x32_bf16 v[56:59], v[16:19], v[240:243], 0
    v_mfma_f32_16x16x32_bf16 v[60:63], v[16:19], v[244:247], 0
    s_sub_u32 s72, s14, 80
    s_mul_i32 s71, s72, 5120
    s_mul_i32 s74, s68, 640
    s_add_u32 s71, s71, s74
    s_add_u32 s71, s71, 589824
    v_and_b32 v6, 1, v3
    v_cmp_eq_u32 vcc, 1, v6
    v_mul_u32_u24 v6, 2560, v6
    v_lshl_add_u32 v6, v2, 3, v6
    v_add_u32 v6, s71, v6
    s_nop 4
    s_mov_b32 exec_lo, -1
    s_mov_b32 exec_hi, 0
    v_cndmask_b32 v20, v24, v25, vcc
    v_cndmask_b32 v21, v28, v29, vcc
    buffer_store_dwordx2 v[20:21], v6, s[60:63], 0 offen offset:0 sc1
    s_nop 0
    v_cndmask_b32 v20, v32, v33, vcc
    v_cndmask_b32 v21, v36, v37, vcc
    buffer_store_dwordx2 v[20:21], v6, s[60:63], 0 offen offset:128 sc1
    s_nop 0
    v_cndmask_b32 v20, v40, v41, vcc
    v_cndmask_b32 v21, v44, v45, vcc
    buffer_store_dwordx2 v[20:21], v6, s[60:63], 0 offen offset:256 sc1
    s_nop 0
    v_cndmask_b32 v20, v48, v49, vcc
    v_cndmask_b32 v21, v52, v53, vcc
    buffer_store_dwordx2 v[20:21], v6, s[60:63], 0 offen offset:384 sc1
    s_nop 0
    v_cndmask_b32 v20, v56, v57, vcc
    v_cndmask_b32 v21, v60, v61, vcc
    buffer_store_dwordx2 v[20:21], v6, s[60:63], 0 offen offset:512 sc1
    s_mov_b64 exec, -1
    s_branch Lhelp_end
Lrole_z:
    s_cmp_eq_u32 s68, 3
    s_cbranch_scc1 Lfin_x
Lfin_d:
    s_sub_u32 s72, s14, 134
    s_cmp_ge_u32 s72, 20
    s_cselect_b32 s73, 1, 0
    s_mul_i32 s74, s73, 20
    s_sub_u32 s72, s72, s74
    s_mul_i32 s71, s73, 2560
    s_lshl_b32 s74, s72, 7
    s_add_u32 s71, s71, s74
    s_add_u32 s71, s71, 589824
    s_lshl_b32 s74, s3, 3
    v_lshrrev_b32 v6, 3, v1
    v_add_u32 v6, s74, v6
    v_cmp_gt_u32 vcc, 54, v6
    v_mul_u32_u24 v6, 5120, v6
    v_and_b32 v7, 7, v1
    v_lshl_add_u32 v6, v7, 4, v6
    v_add_u32 v6, s71, v6
    v_mov_b32 v16, 0
    v_mov_b32 v17, 0
    v_mov_b32 v18, 0
    v_mov_b32 v19, 0
    s_and_b64 exec, exec, vcc
    s_mov_b64 s[34:35], exec
    s_mov_b32 s33, 0x8000
Lpoll_38:
    buffer_load_dwordx4 v[16:19], v6, s[60:63], 0 offen sc1
    s_waitcnt vmcnt(0)
    v_max3_u32 v20, v16, v17, v18
    v_max3_u32 v20, v20, v19, v19
    v_cmp_eq_u32 s[38:39], -1, v20
    s_and_b64 exec, exec, s[38:39]
    s_cbranch_execz Lpolld_39
    s_sub_u32 s33, s33, 1
    s_cmp_eq_u32 s33, 0
    s_cbranch_scc0 Lpoll_38
Lpolld_39:
    s_mov_b64 exec, s[34:35]
    s_mov_b64 exec, -1
    s_nop 1
    v_add_f32_dpp v16, v16, v16 row_ror:8 row_mask:0xf bank_mask:0xf
    v_mov_b32 v20, v16
    s_nop 1
    v_permlane16_swap_b32 v16, v20
    v_add_f32 v16, v16, v20
    v_mov_b32 v20, v16
    s_nop 1
    v_permlane32_swap_b32 v16, v20
    v_add_f32 v16, v16, v20
    s_nop 1
    v_add_f32_dpp v17, v17, v17 row_ror:8 row_mask:0xf bank_mask:0xf
    v_mov_b32 v20, v17
    s_nop 1
    v_permlane16_swap_b32 v17, v20
    v_add_f32 v17, v17, v20
    v_mov_b32 v20, v17
    s_nop 1
    v_permlane32_swap_b32 v17, v20
    v_add_f32 v17, v17, v20
    s_nop 1
    v_add_f32_dpp v18, v18, v18 row_ror:8 row_mask:0xf bank_mask:0xf
    v_mov_b32 v20, v18
    s_nop 1
    v_permlane16_swap_b32 v18, v20
    v_add_f32 v18, v18, v20
    v_mov_b32 v20, v18
    s_nop 1
    v_permlane32_swap_b32 v18, v20
    v_add_f32 v18, v18, v20
    s_nop 1
    v_add_f32_dpp v19, v19, v19 row_ror:8 row_mask:0xf bank_mask:0xf
    v_mov_b32 v20, v19
    s_nop 1
    v_permlane16_swap_b32 v19, v20
    v_add_f32 v19, v19, v20
    v_mov_b32 v20, v19
    s_nop 1
    v_permlane32_swap_b32 v19, v20
    v_add_f32 v19, v19, v20
    s_lshl_b32 s74, s3, 7
    s_add_u32 s74, s74, 158336
    v_lshl_add_u32 v6, v7, 4, s74
    s_mov_b64 exec, 0xff
    ds_write_b128 v6, v[16:19]
    s_mov_b64 exec, -1
    s_waitcnt lgkmcnt(0)
    s_barrier
    s_cmp_lt_u32 s3, 4
    s_cbranch_scc1 Lend
    s_branch Lhelp_end
Lfin_x:
    s_sub_u32 s72, s14, 134
    s_cmp_ge_u32 s72, 20
    s_cselect_b32 s73, 1, 0
    s_mul_i32 s74, s73, 20
    s_sub_u32 s72, s72, s74
    s_mul_i32 s71, s73, 2560
    s_lshl_b32 s74, s72, 7
    s_add_u32 s71, s71, s74
    s_add_u32 s71, s71, 524288
    v_lshrrev_b32 v9, 3, v1
    v_mul_u32_u24 v6, 5120, v9
    v_and_b32 v7, 7, v1
    v_lshl_add_u32 v6, v7, 4, v6
    v_add_u32 v6, s71, v6
    s_mov_b64 s[34:35], exec
    s_mov_b32 s33, 0x8000
Lpoll_40:
    buffer_load_dwordx4 v[16:19], v6, s[60:63], 0 offen sc1
    s_waitcnt vmcnt(0)
    v_max3_u32 v20, v16, v17, v18
    v_max3_u32 v20, v20, v19, v19
    v_cmp_eq_u32 s[38:39], -1, v20
    s_and_b64 exec, exec, s[38:39]
    s_cbranch_execz Lpolld_41
    s_sub_u32 s33, s33, 1
    s_cmp_eq_u32 s33, 0
    s_cbranch_scc0 Lpoll_40
Lpolld_41:
    s_mov_b64 exec, s[34:35]
    s_nop 1
    v_add_f32_dpp v16, v16, v16 row_ror:8 row_mask:0xf bank_mask:0xf
    v_mov_b32 v20, v16
    s_nop 1
    v_permlane16_swap_b32 v16, v20
    v_add_f32 v16, v16, v20
    v_mov_b32 v20, v16
    s_nop 1
    v_permlane32_swap_b32 v16, v20
    v_add_f32 v16, v16, v20
    v_cvt_pk_bf16_f32 v16, v16, v16
    v_lshlrev_b32 v16, 16, v16
    v_mul_f32 v16, v16, v128
    v_cvt_pk_bf16_f32 v16, v16, v16
    v_lshlrev_b32 v16, 16, v16
    v_add_f32 v16, v16, v136
    v_cvt_pk_bf16_f32 v16, v16, v16
    v_lshlrev_b32 v16, 16, v16
    s_nop 1
    v_add_f32_dpp v17, v17, v17 row_ror:8 row_mask:0xf bank_mask:0xf
    v_mov_b32 v20, v17
    s_nop 1
    v_permlane16_swap_b32 v17, v20
    v_add_f32 v17, v17, v20
    v_mov_b32 v20, v17
    s_nop 1
    v_permlane32_swap_b32 v17, v20
    v_add_f32 v17, v17, v20
    v_cvt_pk_bf16_f32 v17, v17, v17
    v_lshlrev_b32 v17, 16, v17
    v_mul_f32 v17, v17, v129
    v_cvt_pk_bf16_f32 v17, v17, v17
    v_lshlrev_b32 v17, 16, v17
    v_add_f32 v17, v17, v137
    v_cvt_pk_bf16_f32 v17, v17, v17
    v_lshlrev_b32 v17, 16, v17
    s_nop 1
    v_add_f32_dpp v18, v18, v18 row_ror:8 row_mask:0xf bank_mask:0xf
    v_mov_b32 v20, v18
    s_nop 1
    v_permlane16_swap_b32 v18, v20
    v_add_f32 v18, v18, v20
    v_mov_b32 v20, v18
    s_nop 1
    v_permlane32_swap_b32 v18, v20
    v_add_f32 v18, v18, v20
    v_cvt_pk_bf16_f32 v18, v18, v18
    v_lshlrev_b32 v18, 16, v18
    v_mul_f32 v18, v18, v130
    v_cvt_pk_bf16_f32 v18, v18, v18
    v_lshlrev_b32 v18, 16, v18
    v_add_f32 v18, v18, v138
    v_cvt_pk_bf16_f32 v18, v18, v18
    v_lshlrev_b32 v18, 16, v18
    s_nop 1
    v_add_f32_dpp v19, v19, v19 row_ror:8 row_mask:0xf bank_mask:0xf
    v_mov_b32 v20, v19
    s_nop 1
    v_permlane16_swap_b32 v19, v20
    v_add_f32 v19, v19, v20
    v_mov_b32 v20, v19
    s_nop 1
    v_permlane32_swap_b32 v19, v20
    v_add_f32 v19, v19, v20
    v_cvt_pk_bf16_f32 v19, v19, v19
    v_lshlrev_b32 v19, 16, v19
    v_mul_f32 v19, v19, v131
    v_cvt_pk_bf16_f32 v19, v19, v19
    v_lshlrev_b32 v19, 16, v19
    v_add_f32 v19, v19, v139
    v_cvt_pk_bf16_f32 v19, v19, v19
    v_lshlrev_b32 v19, 16, v19
    v_min_u32 v9, 6, v9
    v_lshlrev_b32 v6, 7, v9
    v_lshl_add_u32 v6, v7, 4, v6
    v_add_u32 v6, 158336, v6
    v_lshrrev_b32 v9, 3, v1
    s_barrier
    ds_read_b128 v[24:27], v6
    v_cmp_gt_u32 vcc, 7, v9
    s_waitcnt lgkmcnt(0)
    v_cndmask_b32 v24, 0, v24, vcc
    v_cndmask_b32 v25, 0, v25, vcc
    v_cndmask_b32 v26, 0, v26, vcc
    v_cndmask_b32 v27, 0, v27, vcc
    s_nop 1
    v_add_f32_dpp v24, v24, v24 row_ror:8 row_mask:0xf bank_mask:0xf
    v_mov_b32 v20, v24
    s_nop 1
    v_permlane16_swap_b32 v24, v20
    v_add_f32 v24, v24, v20
    v_mov_b32 v20, v24
    s_nop 1
    v_permlane32_swap_b32 v24, v20
    v_add_f32 v24, v24, v20
    v_cvt_pk_bf16_f32 v24, v24, v24
    v_lshlrev_b32 v24, 16, v24
    v_mul_f32 v24, v24, v132
    v_cvt_pk_bf16_f32 v24, v24, v24
    v_lshlrev_b32 v24, 16, v24
    v_add_f32 v24, v24, v16
    s_nop 1
    v_add_f32_dpp v25, v25, v25 row_ror:8 row_mask:0xf bank_mask:0xf
    v_mov_b32 v20, v25
    s_nop 1
    v_permlane16_swap_b32 v25, v20
    v_add_f32 v25, v25, v20
    v_mov_b32 v20, v25
    s_nop 1
    v_permlane32_swap_b32 v25, v20
    v_add_f32 v25, v25, v20
    v_cvt_pk_bf16_f32 v25, v25, v25
    v_lshlrev_b32 v25, 16, v25
    v_mul_f32 v25, v25, v133
    v_cvt_pk_bf16_f32 v25, v25, v25
    v_lshlrev_b32 v25, 16, v25
    v_add_f32 v25, v25, v17
    s_nop 1
    v_add_f32_dpp v26, v26, v26 row_ror:8 row_mask:0xf bank_mask:0xf
    v_mov_b32 v20, v26
    s_nop 1
    v_permlane16_swap_b32 v26, v20
    v_add_f32 v26, v26, v20
    v_mov_b32 v20, v26
    s_nop 1
    v_permlane32_swap_b32 v26, v20
    v_add_f32 v26, v26, v20
    v_cvt_pk_bf16_f32 v26, v26, v26
    v_lshlrev_b32 v26, 16, v26
    v_mul_f32 v26, v26, v134
    v_cvt_pk_bf16_f32 v26, v26, v26
    v_lshlrev_b32 v26, 16, v26
    v_add_f32 v26, v26, v18
    s_nop 1
    v_add_f32_dpp v27, v27, v27 row_ror:8 row_mask:0xf bank_mask:0xf
    v_mov_b32 v20, v27
    s_nop 1
    v_permlane16_swap_b32 v27, v20
    v_add_f32 v27, v27, v20
    v_mov_b32 v20, v27
    s_nop 1
    v_permlane32_swap_b32 v27, v20
    v_add_f32 v27, v27, v20
    v_cvt_pk_bf16_f32 v27, v27, v27
    v_lshlrev_b32 v27, 16, v27
    v_mul_f32 v27, v27, v135
    v_cvt_pk_bf16_f32 v27, v27, v27
    v_lshlrev_b32 v27, 16, v27
    v_add_f32 v27, v27, v19
    v_cvt_pk_bf16_f32 v24, v24, v25
    v_cvt_pk_bf16_f32 v25, v26, v27
    s_mov_b32 s56, s26
    s_and_b32 s57, s27, 0xffff
    s_mov_b32 s58, 2560
    s_mov_b32 s59, 0x20000
    s_mul_i32 s71, s73, 1280
    s_lshl_b32 s74, s72, 6
    s_add_u32 s71, s71, s74
    v_lshl_add_u32 v6, v7, 3, s71
    s_mov_b64 exec, 0xff
    buffer_store_dwordx2 v[24:25], v6, s[56:59], 0 offen
    s_cmp_eq_u32 s14, 134
    s_cbranch_scc0 Lfin_e
    v_mov_b32 v6, 0
    v_mov_b32 v7, s32
    s_mov_b64 exec, 1
    buffer_store_dword v7, v6, s[60:63], 0 offen sc1
Lfin_e:
    s_mov_b64 exec, -1
Lhelp_end:
Lend:
    s_endpgm
.section .rodata,"a"
.p2align 6
.amdhsa_kernel adaLN_cond__mha_block_cached__swiglu_ffn__decode_kernel
  .amdhsa_next_free_vgpr 256
  .amdhsa_next_free_sgpr 102
  .amdhsa_accum_offset 256
  .amdhsa_group_segment_fixed_size 0
  .amdhsa_kernarg_size 112
  .amdhsa_user_sgpr_count 2
  .amdhsa_user_sgpr_kernarg_segment_ptr 1
  .amdhsa_system_sgpr_workgroup_id_x 1
.end_amdhsa_kernel
```
